```python
import torch

def _softmax(x, axis=-1):
    return torch.softmax(x, dim=axis)
def _gelu(x):
    return torch.nn.functional.gelu(x, approximate="tanh")
def _silu(x):
    return torch.nn.functional.silu(x)
def _sigmoid(x):
    return torch.sigmoid(x)
def _layernorm(x, axis=-1, eps=1e-5):
    m = x.mean(dim=axis, keepdim=True)
    v = x.var(dim=axis, keepdim=True, unbiased=False)
    return (x - m) / torch.sqrt(v + eps)
def _scatter_add(tgt, idx, src, axis=0):
    return tgt.clone().index_add_(axis, idx, src)
def _segment_sum(src, seg, n):
    out = torch.zeros((n,) + src.shape[1:], dtype=src.dtype)
    return out.index_add_(0, seg, src)
def _pad(x, pw):
    flat = tuple(v for pair in reversed(pw) for v in pair)
    return torch.nn.functional.pad(x, flat)

kernel_name = 'sequential_preLN__spectral_gfnet__glu_gated_geglu__prompt'

def setup_inputs():

    _w = (lambda a: (lambda t: t.to(torch.bfloat16) if t.is_floating_point() else t)(torch.as_tensor(a)))
    def _A_setup():
        B, S, D = 1, 2048, 1024
        Df = D // 2 + 1
        return {
            "x": _w((lambda *s: torch.randn(*s, dtype=torch.bfloat16) * 0.05)(B, S, D)),
            "w_r": _w((lambda *s: torch.randn(*s, dtype=torch.bfloat16) * 0.4)(S, Df) * 0.02),
            "w_i": _w((lambda *s: torch.randn(*s, dtype=torch.bfloat16) * 0.4)(S, Df) * 0.02),
        }
    _A_in = _A_setup()

    def _B_setup():
        B, S, Dm, Df = 1, 2048, 1024, 3584
        return {
            "x": _w((lambda *s: torch.randn(*s, dtype=torch.bfloat16) * 0.05)(B, S, Dm)),
            "w_gate": _w((lambda *s: torch.randn(*s, dtype=torch.bfloat16) * 0.4)(Dm, Df) * (Dm ** -0.5)),
            "w_up": _w((lambda *s: torch.randn(*s, dtype=torch.bfloat16) * 0.4)(Dm, Df) * (Dm ** -0.5)),
            "w_down": _w((lambda *s: torch.randn(*s, dtype=torch.bfloat16) * 0.4)(Df, Dm) * (Df ** -0.5)),
        }
    _B_in = _B_setup()

    return {
        "A_x": _A_in["x"],
        "A_w_r": _A_in["w_r"],
        "A_w_i": _A_in["w_i"],
        "B_x": _B_in["x"],
        "B_w_gate": _B_in["w_gate"],
        "B_w_up": _B_in["w_up"],
        "B_w_down": _B_in["w_down"],
    }

def reference(A_x, A_w_r, A_w_i, B_x, B_w_gate, B_w_up, B_w_down):
    def _A_ref(x, w_r, w_i):
        B, S, D = x.shape
        X = (lambda x, axes=(-2,-1): torch.fft.rfft2(x.float(), dim=axes))(x, axes=(-2, -1))
        W = w_r + 1j * w_i
        X = X * W
        y = (lambda x, s, axes=(-2,-1): torch.fft.irfft2(x, s=s, dim=axes).to(torch.bfloat16))(X, (S, D), axes=(-2, -1))
        return y

    def _B_ref(x, w_gate, w_up, w_down):
        g = torch.einsum("bsd,df->bsf", x, w_gate)
        u = torch.einsum("bsd,df->bsf", x, w_up)
        h = _gelu(g) * u
        return torch.einsum("bsf,fd->bsd", h, w_down)

    x = A_x
    h = x + _A_ref(_layernorm(x, axis=-1), A_w_r, A_w_i)
    h2 = h + _B_ref(_layernorm(h, axis=-1), B_w_gate, B_w_up, B_w_down)
    return h2
```

```asm
; @launch kernel=fftA_kernel grid=(531,1,1) block=(512,1,1) lds=16512
; @launch kernel=fftB_kernel grid=(193,1,1) block=(256,1,1) lds=122880
; @launch kernel=fftC_kernel grid=(256,1,1) block=(512,1,1) lds=16384
; @launch kernel=ffn1_kernel grid=(256,1,1) block=(512,1,1) lds=65536
; @launch kernel=ffn2_kernel grid=(256,1,1) block=(256,1,1) lds=131072
.amdgcn_target "amdgcn-amd-amdhsa--gfx950"
.text
.globl fftA_kernel
.p2align 8
.type fftA_kernel,@function
fftA_kernel:
  s_cmp_ge_u32 s2, 531
  s_cbranch_scc1 A_done
  s_cmp_ge_u32 s2, 403
  s_cbranch_scc1 A_pref
  s_load_dwordx2 s[4:5], s[0:1], 0
  s_load_dwordx2 s[6:7], s[0:1], 8
  s_load_dwordx2 s[8:9], s[0:1], 16
  s_load_dwordx2 s[10:11], s[0:1], 72
  v_and_b32 v1, 63, v0
  v_lshrrev_b32 v5, 6, v0
  s_nop 0
  v_readfirstlane_b32 s3, v5
  s_waitcnt lgkmcnt(0)
  s_mov_b32 s12, s4
  s_and_b32 s13, s5, 0xffff
  s_mov_b32 s14, 0x400000
  s_mov_b32 s15, 0x00020000
  s_mov_b32 s16, s10
  s_and_b32 s17, s11, 0xffff
  s_mov_b32 s18, 0x10000000
  s_mov_b32 s19, 0x00020000
  s_cmp_ge_u32 s2, 256
  s_cbranch_scc1 A_roles
  v_and_b32 v2, 15, v1
  v_lshrrev_b32 v3, 4, v1
  s_lshr_b32 s20, s2, 5
  s_and_b32 s21, s2, 31
  s_lshl_b32 s22, s20, 3
  s_add_u32 s22, s22, s3
  s_lshl_b32 s22, s22, 5
  s_add_u32 s22, s22, s21
  s_lshl_b32 s23, s22, 11
  v_lshlrev_b32 v4, 9, v3
  v_lshl_add_u32 v4, v2, 1, v4
  buffer_load_ushort v8, v4, s[12:15], s23 offen offset:0
  buffer_load_ushort v9, v4, s[12:15], s23 offen offset:64
  buffer_load_ushort v10, v4, s[12:15], s23 offen offset:128
  buffer_load_ushort v11, v4, s[12:15], s23 offen offset:192
  buffer_load_ushort v12, v4, s[12:15], s23 offen offset:256
  buffer_load_ushort v13, v4, s[12:15], s23 offen offset:320
  buffer_load_ushort v14, v4, s[12:15], s23 offen offset:384
  buffer_load_ushort v15, v4, s[12:15], s23 offen offset:448
  buffer_load_ushort v16, v4, s[12:15], s23 offen offset:32
  buffer_load_ushort v17, v4, s[12:15], s23 offen offset:96
  buffer_load_ushort v18, v4, s[12:15], s23 offen offset:160
  buffer_load_ushort v19, v4, s[12:15], s23 offen offset:224
  buffer_load_ushort v20, v4, s[12:15], s23 offen offset:288
  buffer_load_ushort v21, v4, s[12:15], s23 offen offset:352
  buffer_load_ushort v22, v4, s[12:15], s23 offen offset:416
  buffer_load_ushort v23, v4, s[12:15], s23 offen offset:480
  v_add_u32 v108, 16, v2
  v_lshlrev_b32 v109, 3, v3
  v_add_u32 v6, 0, v109
  v_mul_u32_u24 v6, v6, v2
  v_and_b32 v7, 31, v6
  v_cvt_f32_u32 v7, v7
  v_mul_f32 v7, 0x3d000000, v7
  v_cos_f32 v24, v7
  v_sin_f32 v32, v7
  v_add_u32 v6, 1, v109
  v_mul_u32_u24 v6, v6, v2
  v_and_b32 v7, 31, v6
  v_cvt_f32_u32 v7, v7
  v_mul_f32 v7, 0x3d000000, v7
  v_cos_f32 v25, v7
  v_sin_f32 v33, v7
  v_add_u32 v6, 2, v109
  v_mul_u32_u24 v6, v6, v2
  v_and_b32 v7, 31, v6
  v_cvt_f32_u32 v7, v7
  v_mul_f32 v7, 0x3d000000, v7
  v_cos_f32 v26, v7
  v_sin_f32 v34, v7
  v_add_u32 v6, 3, v109
  v_mul_u32_u24 v6, v6, v2
  v_and_b32 v7, 31, v6
  v_cvt_f32_u32 v7, v7
  v_mul_f32 v7, 0x3d000000, v7
  v_cos_f32 v27, v7
  v_sin_f32 v35, v7
  v_add_u32 v6, 4, v109
  v_mul_u32_u24 v6, v6, v2
  v_and_b32 v7, 31, v6
  v_cvt_f32_u32 v7, v7
  v_mul_f32 v7, 0x3d000000, v7
  v_cos_f32 v28, v7
  v_sin_f32 v36, v7
  v_add_u32 v6, 5, v109
  v_mul_u32_u24 v6, v6, v2
  v_and_b32 v7, 31, v6
  v_cvt_f32_u32 v7, v7
  v_mul_f32 v7, 0x3d000000, v7
  v_cos_f32 v29, v7
  v_sin_f32 v37, v7
  v_add_u32 v6, 6, v109
  v_mul_u32_u24 v6, v6, v2
  v_and_b32 v7, 31, v6
  v_cvt_f32_u32 v7, v7
  v_mul_f32 v7, 0x3d000000, v7
  v_cos_f32 v30, v7
  v_sin_f32 v38, v7
  v_add_u32 v6, 7, v109
  v_mul_u32_u24 v6, v6, v2
  v_and_b32 v7, 31, v6
  v_cvt_f32_u32 v7, v7
  v_mul_f32 v7, 0x3d000000, v7
  v_cos_f32 v31, v7
  v_sin_f32 v39, v7
  v_cvt_pk_bf16_f32 v40, v24, v25
  v_cvt_pk_bf16_f32 v48, -v32, -v33
  v_cvt_pk_bf16_f32 v41, v26, v27
  v_cvt_pk_bf16_f32 v49, -v34, -v35
  v_cvt_pk_bf16_f32 v42, v28, v29
  v_cvt_pk_bf16_f32 v50, -v36, -v37
  v_cvt_pk_bf16_f32 v43, v30, v31
  v_cvt_pk_bf16_f32 v51, -v38, -v39
  v_add_u32 v6, 0, v109
  v_mul_u32_u24 v6, v6, v108
  v_and_b32 v7, 31, v6
  v_cvt_f32_u32 v7, v7
  v_mul_f32 v7, 0x3d000000, v7
  v_cos_f32 v24, v7
  v_sin_f32 v32, v7
  v_add_u32 v6, 1, v109
  v_mul_u32_u24 v6, v6, v108
  v_and_b32 v7, 31, v6
  v_cvt_f32_u32 v7, v7
  v_mul_f32 v7, 0x3d000000, v7
  v_cos_f32 v25, v7
  v_sin_f32 v33, v7
  v_add_u32 v6, 2, v109
  v_mul_u32_u24 v6, v6, v108
  v_and_b32 v7, 31, v6
  v_cvt_f32_u32 v7, v7
  v_mul_f32 v7, 0x3d000000, v7
  v_cos_f32 v26, v7
  v_sin_f32 v34, v7
  v_add_u32 v6, 3, v109
  v_mul_u32_u24 v6, v6, v108
  v_and_b32 v7, 31, v6
  v_cvt_f32_u32 v7, v7
  v_mul_f32 v7, 0x3d000000, v7
  v_cos_f32 v27, v7
  v_sin_f32 v35, v7
  v_add_u32 v6, 4, v109
  v_mul_u32_u24 v6, v6, v108
  v_and_b32 v7, 31, v6
  v_cvt_f32_u32 v7, v7
  v_mul_f32 v7, 0x3d000000, v7
  v_cos_f32 v28, v7
  v_sin_f32 v36, v7
  v_add_u32 v6, 5, v109
  v_mul_u32_u24 v6, v6, v108
  v_and_b32 v7, 31, v6
  v_cvt_f32_u32 v7, v7
  v_mul_f32 v7, 0x3d000000, v7
  v_cos_f32 v29, v7
  v_sin_f32 v37, v7
  v_add_u32 v6, 6, v109
  v_mul_u32_u24 v6, v6, v108
  v_and_b32 v7, 31, v6
  v_cvt_f32_u32 v7, v7
  v_mul_f32 v7, 0x3d000000, v7
  v_cos_f32 v30, v7
  v_sin_f32 v38, v7
  v_add_u32 v6, 7, v109
  v_mul_u32_u24 v6, v6, v108
  v_and_b32 v7, 31, v6
  v_cvt_f32_u32 v7, v7
  v_mul_f32 v7, 0x3d000000, v7
  v_cos_f32 v31, v7
  v_sin_f32 v39, v7
  v_cvt_pk_bf16_f32 v44, v24, v25
  v_cvt_pk_bf16_f32 v52, -v32, -v33
  v_cvt_pk_bf16_f32 v45, v26, v27
  v_cvt_pk_bf16_f32 v53, -v34, -v35
  v_cvt_pk_bf16_f32 v46, v28, v29
  v_cvt_pk_bf16_f32 v54, -v36, -v37
  v_cvt_pk_bf16_f32 v47, v30, v31
  v_cvt_pk_bf16_f32 v55, -v38, -v39
  v_lshlrev_b32 v110, 2, v3
  v_add_u32 v6, 0, v110
  v_mul_u32_u24 v6, v6, v2
  v_cvt_f32_u32 v7, v6
  v_mul_f32 v7, 0x3a800000, v7
  v_cos_f32 v56, v7
  v_sin_f32 v72, v7
  v_add_u32 v6, 1, v110
  v_mul_u32_u24 v6, v6, v2
  v_cvt_f32_u32 v7, v6
  v_mul_f32 v7, 0x3a800000, v7
  v_cos_f32 v57, v7
  v_sin_f32 v73, v7
  v_add_u32 v6, 2, v110
  v_mul_u32_u24 v6, v6, v2
  v_cvt_f32_u32 v7, v6
  v_mul_f32 v7, 0x3a800000, v7
  v_cos_f32 v58, v7
  v_sin_f32 v74, v7
  v_add_u32 v6, 3, v110
  v_mul_u32_u24 v6, v6, v2
  v_cvt_f32_u32 v7, v6
  v_mul_f32 v7, 0x3a800000, v7
  v_cos_f32 v59, v7
  v_sin_f32 v75, v7
  v_add_u32 v6, 16, v110
  v_mul_u32_u24 v6, v6, v2
  v_cvt_f32_u32 v7, v6
  v_mul_f32 v7, 0x3a800000, v7
  v_cos_f32 v60, v7
  v_sin_f32 v76, v7
  v_add_u32 v6, 17, v110
  v_mul_u32_u24 v6, v6, v2
  v_cvt_f32_u32 v7, v6
  v_mul_f32 v7, 0x3a800000, v7
  v_cos_f32 v61, v7
  v_sin_f32 v77, v7
  v_add_u32 v6, 18, v110
  v_mul_u32_u24 v6, v6, v2
  v_cvt_f32_u32 v7, v6
  v_mul_f32 v7, 0x3a800000, v7
  v_cos_f32 v62, v7
  v_sin_f32 v78, v7
  v_add_u32 v6, 19, v110
  v_mul_u32_u24 v6, v6, v2
  v_cvt_f32_u32 v7, v6
  v_mul_f32 v7, 0x3a800000, v7
  v_cos_f32 v63, v7
  v_sin_f32 v79, v7
  v_add_u32 v6, 0, v110
  v_mul_u32_u24 v6, v6, v108
  v_cvt_f32_u32 v7, v6
  v_mul_f32 v7, 0x3a800000, v7
  v_cos_f32 v64, v7
  v_sin_f32 v80, v7
  v_add_u32 v6, 1, v110
  v_mul_u32_u24 v6, v6, v108
  v_cvt_f32_u32 v7, v6
  v_mul_f32 v7, 0x3a800000, v7
  v_cos_f32 v65, v7
  v_sin_f32 v81, v7
  v_add_u32 v6, 2, v110
  v_mul_u32_u24 v6, v6, v108
  v_cvt_f32_u32 v7, v6
  v_mul_f32 v7, 0x3a800000, v7
  v_cos_f32 v66, v7
  v_sin_f32 v82, v7
  v_add_u32 v6, 3, v110
  v_mul_u32_u24 v6, v6, v108
  v_cvt_f32_u32 v7, v6
  v_mul_f32 v7, 0x3a800000, v7
  v_cos_f32 v67, v7
  v_sin_f32 v83, v7
  v_add_u32 v6, 16, v110
  v_mul_u32_u24 v6, v6, v108
  v_cvt_f32_u32 v7, v6
  v_mul_f32 v7, 0x3a800000, v7
  v_cos_f32 v68, v7
  v_sin_f32 v84, v7
  v_add_u32 v6, 17, v110
  v_mul_u32_u24 v6, v6, v108
  v_cvt_f32_u32 v7, v6
  v_mul_f32 v7, 0x3a800000, v7
  v_cos_f32 v69, v7
  v_sin_f32 v85, v7
  v_add_u32 v6, 18, v110
  v_mul_u32_u24 v6, v6, v108
  v_cvt_f32_u32 v7, v6
  v_mul_f32 v7, 0x3a800000, v7
  v_cos_f32 v70, v7
  v_sin_f32 v86, v7
  v_add_u32 v6, 19, v110
  v_mul_u32_u24 v6, v6, v108
  v_cvt_f32_u32 v7, v6
  v_mul_f32 v7, 0x3a800000, v7
  v_cos_f32 v71, v7
  v_sin_f32 v87, v7
  v_add_u32 v6, 0, v110
  v_mul_u32_u24 v6, v6, v2
  v_and_b32 v7, 31, v6
  v_cvt_f32_u32 v7, v7
  v_mul_f32 v7, 0x3d000000, v7
  v_cos_f32 v24, v7
  v_sin_f32 v32, v7
  v_add_u32 v6, 1, v110
  v_mul_u32_u24 v6, v6, v2
  v_and_b32 v7, 31, v6
  v_cvt_f32_u32 v7, v7
  v_mul_f32 v7, 0x3d000000, v7
  v_cos_f32 v25, v7
  v_sin_f32 v33, v7
  v_add_u32 v6, 2, v110
  v_mul_u32_u24 v6, v6, v2
  v_and_b32 v7, 31, v6
  v_cvt_f32_u32 v7, v7
  v_mul_f32 v7, 0x3d000000, v7
  v_cos_f32 v26, v7
  v_sin_f32 v34, v7
  v_add_u32 v6, 3, v110
  v_mul_u32_u24 v6, v6, v2
  v_and_b32 v7, 31, v6
  v_cvt_f32_u32 v7, v7
  v_mul_f32 v7, 0x3d000000, v7
  v_cos_f32 v27, v7
  v_sin_f32 v35, v7
  v_add_u32 v6, 16, v110
  v_mul_u32_u24 v6, v6, v2
  v_and_b32 v7, 31, v6
  v_cvt_f32_u32 v7, v7
  v_mul_f32 v7, 0x3d000000, v7
  v_cos_f32 v28, v7
  v_sin_f32 v36, v7
  v_add_u32 v6, 17, v110
  v_mul_u32_u24 v6, v6, v2
  v_and_b32 v7, 31, v6
  v_cvt_f32_u32 v7, v7
  v_mul_f32 v7, 0x3d000000, v7
  v_cos_f32 v29, v7
  v_sin_f32 v37, v7
  v_add_u32 v6, 18, v110
  v_mul_u32_u24 v6, v6, v2
  v_and_b32 v7, 31, v6
  v_cvt_f32_u32 v7, v7
  v_mul_f32 v7, 0x3d000000, v7
  v_cos_f32 v30, v7
  v_sin_f32 v38, v7
  v_add_u32 v6, 19, v110
  v_mul_u32_u24 v6, v6, v2
  v_and_b32 v7, 31, v6
  v_cvt_f32_u32 v7, v7
  v_mul_f32 v7, 0x3d000000, v7
  v_cos_f32 v31, v7
  v_sin_f32 v39, v7
  v_cvt_pk_bf16_f32 v88, v24, v25
  v_cvt_pk_bf16_f32 v92, v32, v33
  v_cvt_pk_bf16_f32 v96, -v32, -v33
  v_cvt_pk_bf16_f32 v89, v26, v27
  v_cvt_pk_bf16_f32 v93, v34, v35
  v_cvt_pk_bf16_f32 v97, -v34, -v35
  v_cvt_pk_bf16_f32 v90, v28, v29
  v_cvt_pk_bf16_f32 v94, v36, v37
  v_cvt_pk_bf16_f32 v98, -v36, -v37
  v_cvt_pk_bf16_f32 v91, v30, v31
  v_cvt_pk_bf16_f32 v95, v38, v39
  v_cvt_pk_bf16_f32 v99, -v38, -v39
  s_waitcnt vmcnt(0)
  v_lshlrev_b32 v8, 16, v8
  v_lshlrev_b32 v9, 16, v9
  v_lshlrev_b32 v10, 16, v10
  v_lshlrev_b32 v11, 16, v11
  v_lshlrev_b32 v12, 16, v12
  v_lshlrev_b32 v13, 16, v13
  v_lshlrev_b32 v14, 16, v14
  v_lshlrev_b32 v15, 16, v15
  v_lshlrev_b32 v16, 16, v16
  v_lshlrev_b32 v17, 16, v17
  v_lshlrev_b32 v18, 16, v18
  v_lshlrev_b32 v19, 16, v19
  v_lshlrev_b32 v20, 16, v20
  v_lshlrev_b32 v21, 16, v21
  v_lshlrev_b32 v22, 16, v22
  v_lshlrev_b32 v23, 16, v23
  v_add_f32 v111, v8, v9
  v_add_f32 v111, v111, v10
  v_add_f32 v111, v111, v11
  v_add_f32 v111, v111, v12
  v_add_f32 v111, v111, v13
  v_add_f32 v111, v111, v14
  v_add_f32 v111, v111, v15
  v_add_f32 v111, v111, v16
  v_add_f32 v111, v111, v17
  v_add_f32 v111, v111, v18
  v_add_f32 v111, v111, v19
  v_add_f32 v111, v111, v20
  v_add_f32 v111, v111, v21
  v_add_f32 v111, v111, v22
  v_add_f32 v111, v111, v23
  ds_swizzle_b32 v112, v111 offset:0x041F
  s_waitcnt lgkmcnt(0)
  v_add_f32 v111, v111, v112
  ds_swizzle_b32 v112, v111 offset:0x081F
  s_waitcnt lgkmcnt(0)
  v_add_f32 v111, v111, v112
  ds_swizzle_b32 v112, v111 offset:0x101F
  s_waitcnt lgkmcnt(0)
  v_add_f32 v111, v111, v112
  ds_swizzle_b32 v112, v111 offset:0x201F
  s_waitcnt lgkmcnt(0)
  v_add_f32 v111, v111, v112
  ds_swizzle_b32 v112, v111 offset:0x401F
  s_waitcnt lgkmcnt(0)
  v_add_f32 v111, v111, v112
  s_nop 0
  v_readlane_b32 s24, v111, 0
  v_readlane_b32 s25, v111, 32
  s_nop 0
  v_mov_b32 v111, s24
  v_add_f32 v111, s25, v111
  v_mul_f32 v111, 0x3a800000, v111
  v_sub_f32 v24, v8, v111
  v_sub_f32 v25, v9, v111
  v_sub_f32 v26, v10, v111
  v_sub_f32 v27, v11, v111
  v_sub_f32 v28, v12, v111
  v_sub_f32 v29, v13, v111
  v_sub_f32 v30, v14, v111
  v_sub_f32 v31, v15, v111
  v_sub_f32 v32, v16, v111
  v_sub_f32 v33, v17, v111
  v_sub_f32 v34, v18, v111
  v_sub_f32 v35, v19, v111
  v_sub_f32 v36, v20, v111
  v_sub_f32 v37, v21, v111
  v_sub_f32 v38, v22, v111
  v_sub_f32 v39, v23, v111
  v_mul_f32 v113, v24, v24
  v_fmac_f32 v113, v25, v25
  v_fmac_f32 v113, v26, v26
  v_fmac_f32 v113, v27, v27
  v_fmac_f32 v113, v28, v28
  v_fmac_f32 v113, v29, v29
  v_fmac_f32 v113, v30, v30
  v_fmac_f32 v113, v31, v31
  v_fmac_f32 v113, v32, v32
  v_fmac_f32 v113, v33, v33
  v_fmac_f32 v113, v34, v34
  v_fmac_f32 v113, v35, v35
  v_fmac_f32 v113, v36, v36
  v_fmac_f32 v113, v37, v37
  v_fmac_f32 v113, v38, v38
  v_fmac_f32 v113, v39, v39
  ds_swizzle_b32 v114, v113 offset:0x041F
  s_waitcnt lgkmcnt(0)
  v_add_f32 v113, v113, v114
  ds_swizzle_b32 v114, v113 offset:0x081F
  s_waitcnt lgkmcnt(0)
  v_add_f32 v113, v113, v114
  ds_swizzle_b32 v114, v113 offset:0x101F
  s_waitcnt lgkmcnt(0)
  v_add_f32 v113, v113, v114
  ds_swizzle_b32 v114, v113 offset:0x201F
  s_waitcnt lgkmcnt(0)
  v_add_f32 v113, v113, v114
  ds_swizzle_b32 v114, v113 offset:0x401F
  s_waitcnt lgkmcnt(0)
  v_add_f32 v113, v113, v114
  s_nop 0
  v_readlane_b32 s24, v113, 0
  v_readlane_b32 s25, v113, 32
  s_nop 0
  v_mov_b32 v113, s24
  v_add_f32 v113, s25, v113
  v_mul_f32 v113, 0x3a800000, v113
  v_cvt_pk_bf16_f32 v112, v111, v113
  v_lshlrev_b32 v111, 16, v112
  v_and_b32 v113, 0xffff0000, v112
  v_add_f32 v113, 0x3727c5ac, v113
  v_cvt_pk_bf16_f32 v113, v113, v113
  v_and_b32 v113, 0xffff0000, v113
  v_sqrt_f32 v113, v113
  s_nop 0
  v_cvt_pk_bf16_f32 v113, v113, v113
  v_and_b32 v113, 0xffff0000, v113
  v_rcp_f32 v113, v113
  v_sub_f32 v24, v8, v111
  v_sub_f32 v25, v9, v111
  v_cvt_pk_bf16_f32 v6, v24, v25
  v_lshlrev_b32 v24, 16, v6
  v_and_b32 v25, 0xffff0000, v6
  v_mul_f32 v24, v24, v113
  v_mul_f32 v25, v25, v113
  v_cvt_pk_bf16_f32 v100, v24, v25
  v_sub_f32 v26, v10, v111
  v_sub_f32 v27, v11, v111
  v_cvt_pk_bf16_f32 v6, v26, v27
  v_lshlrev_b32 v26, 16, v6
  v_and_b32 v27, 0xffff0000, v6
  v_mul_f32 v26, v26, v113
  v_mul_f32 v27, v27, v113
  v_cvt_pk_bf16_f32 v101, v26, v27
  v_sub_f32 v28, v12, v111
  v_sub_f32 v29, v13, v111
  v_cvt_pk_bf16_f32 v6, v28, v29
  v_lshlrev_b32 v28, 16, v6
  v_and_b32 v29, 0xffff0000, v6
  v_mul_f32 v28, v28, v113
  v_mul_f32 v29, v29, v113
  v_cvt_pk_bf16_f32 v102, v28, v29
  v_sub_f32 v30, v14, v111
  v_sub_f32 v31, v15, v111
  v_cvt_pk_bf16_f32 v6, v30, v31
  v_lshlrev_b32 v30, 16, v6
  v_and_b32 v31, 0xffff0000, v6
  v_mul_f32 v30, v30, v113
  v_mul_f32 v31, v31, v113
  v_cvt_pk_bf16_f32 v103, v30, v31
  v_sub_f32 v32, v16, v111
  v_sub_f32 v33, v17, v111
  v_cvt_pk_bf16_f32 v6, v32, v33
  v_lshlrev_b32 v32, 16, v6
  v_and_b32 v33, 0xffff0000, v6
  v_mul_f32 v32, v32, v113
  v_mul_f32 v33, v33, v113
  v_cvt_pk_bf16_f32 v104, v32, v33
  v_sub_f32 v34, v18, v111
  v_sub_f32 v35, v19, v111
  v_cvt_pk_bf16_f32 v6, v34, v35
  v_lshlrev_b32 v34, 16, v6
  v_and_b32 v35, 0xffff0000, v6
  v_mul_f32 v34, v34, v113
  v_mul_f32 v35, v35, v113
  v_cvt_pk_bf16_f32 v105, v34, v35
  v_sub_f32 v36, v20, v111
  v_sub_f32 v37, v21, v111
  v_cvt_pk_bf16_f32 v6, v36, v37
  v_lshlrev_b32 v36, 16, v6
  v_and_b32 v37, 0xffff0000, v6
  v_mul_f32 v36, v36, v113
  v_mul_f32 v37, v37, v113
  v_cvt_pk_bf16_f32 v106, v36, v37
  v_sub_f32 v38, v22, v111
  v_sub_f32 v39, v23, v111
  v_cvt_pk_bf16_f32 v6, v38, v39
  v_lshlrev_b32 v38, 16, v6
  v_and_b32 v39, 0xffff0000, v6
  v_mul_f32 v38, v38, v113
  v_mul_f32 v39, v39, v113
  v_cvt_pk_bf16_f32 v107, v38, v39
  v_mfma_f32_16x16x32_bf16 v[8:11], v[100:103], v[40:43], 0
  v_mfma_f32_16x16x32_bf16 v[24:27], v[100:103], v[48:51], 0
  v_mfma_f32_16x16x32_bf16 v[12:15], v[104:107], v[40:43], 0
  v_mfma_f32_16x16x32_bf16 v[28:31], v[104:107], v[48:51], 0
  v_mfma_f32_16x16x32_bf16 v[16:19], v[100:103], v[44:47], 0
  v_mfma_f32_16x16x32_bf16 v[32:35], v[100:103], v[52:55], 0
  v_mfma_f32_16x16x32_bf16 v[20:23], v[104:107], v[44:47], 0
  v_mfma_f32_16x16x32_bf16 v[36:39], v[104:107], v[52:55], 0
  v_lshlrev_b32 v115, 16, v100
  v_and_b32 v6, 0xffff0000, v100
  v_add_f32 v115, v115, v6
  v_lshlrev_b32 v6, 16, v101
  v_add_f32 v115, v115, v6
  v_and_b32 v6, 0xffff0000, v101
  v_add_f32 v115, v115, v6
  v_lshlrev_b32 v6, 16, v102
  v_add_f32 v115, v115, v6
  v_and_b32 v6, 0xffff0000, v102
  v_add_f32 v115, v115, v6
  v_lshlrev_b32 v6, 16, v103
  v_add_f32 v115, v115, v6
  v_and_b32 v6, 0xffff0000, v103
  v_add_f32 v115, v115, v6
  v_lshlrev_b32 v6, 16, v104
  v_add_f32 v115, v115, v6
  v_and_b32 v6, 0xffff0000, v104
  v_add_f32 v115, v115, v6
  v_lshlrev_b32 v6, 16, v105
  v_add_f32 v115, v115, v6
  v_and_b32 v6, 0xffff0000, v105
  v_add_f32 v115, v115, v6
  v_lshlrev_b32 v6, 16, v106
  v_add_f32 v115, v115, v6
  v_and_b32 v6, 0xffff0000, v106
  v_add_f32 v115, v115, v6
  v_lshlrev_b32 v6, 16, v107
  v_add_f32 v115, v115, v6
  v_and_b32 v6, 0xffff0000, v107
  v_add_f32 v115, v115, v6
  v_lshlrev_b32 v6, 31, v1
  v_xor_b32 v115, v115, v6
  ds_swizzle_b32 v116, v115 offset:0x041F
  s_waitcnt lgkmcnt(0)
  v_add_f32 v115, v115, v116
  ds_swizzle_b32 v116, v115 offset:0x081F
  s_waitcnt lgkmcnt(0)
  v_add_f32 v115, v115, v116
  ds_swizzle_b32 v116, v115 offset:0x101F
  s_waitcnt lgkmcnt(0)
  v_add_f32 v115, v115, v116
  ds_swizzle_b32 v116, v115 offset:0x201F
  s_waitcnt lgkmcnt(0)
  v_add_f32 v115, v115, v116
  ds_swizzle_b32 v116, v115 offset:0x401F
  s_waitcnt lgkmcnt(0)
  v_add_f32 v115, v115, v116
  s_nop 0
  v_readlane_b32 s24, v115, 0
  v_readlane_b32 s25, v115, 32
  s_nop 0
  v_mov_b32 v115, s24
  v_add_f32 v115, s25, v115
  v_pk_mul_f32 v[120:121], v[8:9], v[56:57]
  v_pk_mul_f32 v[122:123], v[24:25], v[56:57]
  v_pk_fma_f32 v[120:121], v[24:25], v[72:73], v[120:121]
  v_pk_fma_f32 v[122:123], v[8:9], v[72:73], v[122:123] neg_lo:[1,0,0] neg_hi:[1,0,0]
  v_cvt_pk_bf16_f32 v40, v120, v121
  v_cvt_pk_bf16_f32 v48, v122, v123
  v_pk_mul_f32 v[120:121], v[10:11], v[58:59]
  v_pk_mul_f32 v[122:123], v[26:27], v[58:59]
  v_pk_fma_f32 v[120:121], v[26:27], v[74:75], v[120:121]
  v_pk_fma_f32 v[122:123], v[10:11], v[74:75], v[122:123] neg_lo:[1,0,0] neg_hi:[1,0,0]
  v_cvt_pk_bf16_f32 v41, v120, v121
  v_cvt_pk_bf16_f32 v49, v122, v123
  v_pk_mul_f32 v[120:121], v[12:13], v[60:61]
  v_pk_mul_f32 v[122:123], v[28:29], v[60:61]
  v_pk_fma_f32 v[120:121], v[28:29], v[76:77], v[120:121]
  v_pk_fma_f32 v[122:123], v[12:13], v[76:77], v[122:123] neg_lo:[1,0,0] neg_hi:[1,0,0]
  v_cvt_pk_bf16_f32 v42, v120, v121
  v_cvt_pk_bf16_f32 v50, v122, v123
  v_pk_mul_f32 v[120:121], v[14:15], v[62:63]
  v_pk_mul_f32 v[122:123], v[30:31], v[62:63]
  v_pk_fma_f32 v[120:121], v[30:31], v[78:79], v[120:121]
  v_pk_fma_f32 v[122:123], v[14:15], v[78:79], v[122:123] neg_lo:[1,0,0] neg_hi:[1,0,0]
  v_cvt_pk_bf16_f32 v43, v120, v121
  v_cvt_pk_bf16_f32 v51, v122, v123
  v_pk_mul_f32 v[120:121], v[16:17], v[64:65]
  v_pk_mul_f32 v[122:123], v[32:33], v[64:65]
  v_pk_fma_f32 v[120:121], v[32:33], v[80:81], v[120:121]
  v_pk_fma_f32 v[122:123], v[16:17], v[80:81], v[122:123] neg_lo:[1,0,0] neg_hi:[1,0,0]
  v_cvt_pk_bf16_f32 v44, v120, v121
  v_cvt_pk_bf16_f32 v52, v122, v123
  v_pk_mul_f32 v[120:121], v[18:19], v[66:67]
  v_pk_mul_f32 v[122:123], v[34:35], v[66:67]
  v_pk_fma_f32 v[120:121], v[34:35], v[82:83], v[120:121]
  v_pk_fma_f32 v[122:123], v[18:19], v[82:83], v[122:123] neg_lo:[1,0,0] neg_hi:[1,0,0]
  v_cvt_pk_bf16_f32 v45, v120, v121
  v_cvt_pk_bf16_f32 v53, v122, v123
  v_pk_mul_f32 v[120:121], v[20:21], v[68:69]
  v_pk_mul_f32 v[122:123], v[36:37], v[68:69]
  v_pk_fma_f32 v[120:121], v[36:37], v[84:85], v[120:121]
  v_pk_fma_f32 v[122:123], v[20:21], v[84:85], v[122:123] neg_lo:[1,0,0] neg_hi:[1,0,0]
  v_cvt_pk_bf16_f32 v46, v120, v121
  v_cvt_pk_bf16_f32 v54, v122, v123
  v_pk_mul_f32 v[120:121], v[22:23], v[70:71]
  v_pk_mul_f32 v[122:123], v[38:39], v[70:71]
  v_pk_fma_f32 v[120:121], v[38:39], v[86:87], v[120:121]
  v_pk_fma_f32 v[122:123], v[22:23], v[86:87], v[122:123] neg_lo:[1,0,0] neg_hi:[1,0,0]
  v_cvt_pk_bf16_f32 v47, v120, v121
  v_cvt_pk_bf16_f32 v55, v122, v123
  v_mfma_f32_16x16x32_bf16 v[8:11], v[88:91], v[40:43], 0
  v_mfma_f32_16x16x32_bf16 v[24:27], v[88:91], v[48:51], 0
  v_mfma_f32_16x16x32_bf16 v[8:11], v[92:95], v[48:51], v[8:11]
  v_mfma_f32_16x16x32_bf16 v[24:27], v[96:99], v[40:43], v[24:27]
  v_mfma_f32_16x16x32_bf16 v[12:15], v[88:91], v[44:47], 0
  v_mfma_f32_16x16x32_bf16 v[28:31], v[88:91], v[52:55], 0
  v_mfma_f32_16x16x32_bf16 v[12:15], v[92:95], v[52:55], v[12:15]
  v_mfma_f32_16x16x32_bf16 v[28:31], v[96:99], v[44:47], v[28:31]
  v_lshlrev_b32 v117, 12, v3
  v_lshl_add_u32 v117, v2, 5, v117
  s_lshl_b32 s24, s3, 1
  v_add_u32 v117, s24, v117
  v_cvt_pk_bf16_f32 v56, v8, v24
  ds_write_b16 v117, v56 offset:0
  ds_write_b16_d16_hi v117, v56 offset:16
  v_cvt_pk_bf16_f32 v57, v9, v25
  ds_write_b16 v117, v57 offset:1024
  ds_write_b16_d16_hi v117, v57 offset:1040
  v_cvt_pk_bf16_f32 v58, v10, v26
  ds_write_b16 v117, v58 offset:2048
  ds_write_b16_d16_hi v117, v58 offset:2064
  v_cvt_pk_bf16_f32 v59, v11, v27
  ds_write_b16 v117, v59 offset:3072
  ds_write_b16_d16_hi v117, v59 offset:3088
  v_cvt_pk_bf16_f32 v60, v12, v28
  ds_write_b16 v117, v60 offset:512
  ds_write_b16_d16_hi v117, v60 offset:528
  v_cvt_pk_bf16_f32 v61, v13, v29
  ds_write_b16 v117, v61 offset:1536
  ds_write_b16_d16_hi v117, v61 offset:1552
  v_cvt_pk_bf16_f32 v62, v14, v30
  ds_write_b16 v117, v62 offset:2560
  ds_write_b16_d16_hi v117, v62 offset:2576
  v_cvt_pk_bf16_f32 v63, v15, v31
  ds_write_b16 v117, v63 offset:3584
  ds_write_b16_d16_hi v117, v63 offset:3600
  v_cvt_pk_bf16_f32 v115, v115, 0
  v_mov_b32 v118, s24
  ds_write_b16 v118, v115 offset:16384
  ds_write_b16_d16_hi v118, v115 offset:16400
  s_waitcnt lgkmcnt(0)
  s_barrier
  v_lshlrev_b32 v117, 5, v0
  ds_read_b128 v[100:103], v117
  ds_read_b128 v[104:107], v117 offset:16
  s_lshl_b32 s24, s21, 8
  s_lshl_b32 s25, s20, 5
  s_add_u32 s24, s24, s25
  s_add_u32 s24, s24, 0x0
  v_lshlrev_b32 v118, 13, v0
  s_waitcnt lgkmcnt(0)
  buffer_store_dwordx4 v[100:103], v118, s[16:19], s24 offen
  buffer_store_dwordx4 v[104:107], v118, s[16:19], s24 offen offset:16
  s_cmp_lg_u32 s3, 0
  s_cbranch_scc1 A_done
  v_cmp_eq_u32 vcc, 0, v1
  s_nop 0
  s_and_saveexec_b64 s[26:27], vcc
  v_mov_b32 v117, 16384
  ds_read_b128 v[8:11], v117
  ds_read_b128 v[12:15], v117 offset:16
  v_mov_b32 v118, 0x400000
  s_waitcnt lgkmcnt(0)
  buffer_store_dwordx4 v[8:11], v118, s[16:19], s24 offen
  buffer_store_dwordx4 v[12:15], v118, s[16:19], s24 offen offset:16
  s_branch A_done
A_roles:
  s_cmp_ge_u32 s2, 400
  s_cbranch_scc1 A_tabs
  s_mov_b32 s20, s6
  s_and_b32 s21, s7, 0xffff
  s_mov_b32 s22, 0x201000
  s_mov_b32 s23, 0x00020000
  s_mov_b32 s24, s8
  s_and_b32 s25, s9, 0xffff
  s_mov_b32 s26, 0x201000
  s_mov_b32 s27, 0x00020000
  s_sub_u32 s28, s2, 256
  s_mul_i32 s29, s28, 57
  s_lshr_b32 s29, s29, 9
  s_mul_i32 s30, s29, 9
  s_sub_u32 s30, s28, s30
  s_lshl_b32 s31, s29, 3
  s_add_u32 s31, s31, s3
  s_lshl_b32 s31, s31, 2
  s_lshl_b32 s32, s30, 6
  v_add_u32 v2, s32, v1
  v_lshlrev_b32 v3, 1, v2
  v_lshlrev_b32 v4, 13, v2
  v_mov_b32 v5, 0x35800000
  v_mov_b32 v6, 0x35000000
  v_cmp_eq_u32 vcc, 0, v2
  s_nop 1
  v_cndmask_b32 v5, v5, v6, vcc
  v_cmp_eq_u32 vcc, 512, v2
  s_nop 1
  v_cndmask_b32 v5, v5, v6, vcc
  s_add_u32 s33, s31, 0
  s_and_b32 s34, s33, 31
  s_lshr_b32 s35, s33, 5
  s_and_b32 s35, s35, 1
  s_lshr_b32 s36, s33, 6
  s_lshr_b32 s37, s36, 2
  s_and_b32 s36, s36, 3
  s_lshl_b32 s37, s37, 5
  s_add_u32 s34, s34, s37
  s_lshl_b32 s36, s36, 3
  s_lshl_b32 s35, s35, 2
  s_add_u32 s36, s36, s35
  s_lshl_b32 s36, s36, 6
  s_add_u32 s34, s34, s36
  s_mul_i32 s34, s34, 1026
  s_add_u32 s38, s34, 0
  s_add_u32 s39, s34, 65664
  s_add_u32 s40, s34, 131328
  s_add_u32 s41, s34, 196992
  buffer_load_ushort v12, v3, s[20:23], s38 offen
  buffer_load_ushort v16, v3, s[24:27], s38 offen
  buffer_load_ushort v13, v3, s[20:23], s39 offen
  buffer_load_ushort v17, v3, s[24:27], s39 offen
  buffer_load_ushort v14, v3, s[20:23], s40 offen
  buffer_load_ushort v18, v3, s[24:27], s40 offen
  buffer_load_ushort v15, v3, s[20:23], s41 offen
  buffer_load_ushort v19, v3, s[24:27], s41 offen
  s_add_u32 s33, s31, 1
  s_and_b32 s34, s33, 31
  s_lshr_b32 s35, s33, 5
  s_and_b32 s35, s35, 1
  s_lshr_b32 s36, s33, 6
  s_lshr_b32 s37, s36, 2
  s_and_b32 s36, s36, 3
  s_lshl_b32 s37, s37, 5
  s_add_u32 s34, s34, s37
  s_lshl_b32 s36, s36, 3
  s_lshl_b32 s35, s35, 2
  s_add_u32 s36, s36, s35
  s_lshl_b32 s36, s36, 6
  s_add_u32 s34, s34, s36
  s_mul_i32 s34, s34, 1026
  s_add_u32 s38, s34, 0
  s_add_u32 s39, s34, 65664
  s_add_u32 s40, s34, 131328
  s_add_u32 s41, s34, 196992
  buffer_load_ushort v20, v3, s[20:23], s38 offen
  buffer_load_ushort v24, v3, s[24:27], s38 offen
  buffer_load_ushort v21, v3, s[20:23], s39 offen
  buffer_load_ushort v25, v3, s[24:27], s39 offen
  buffer_load_ushort v22, v3, s[20:23], s40 offen
  buffer_load_ushort v26, v3, s[24:27], s40 offen
  buffer_load_ushort v23, v3, s[20:23], s41 offen
  buffer_load_ushort v27, v3, s[24:27], s41 offen
  s_add_u32 s33, s31, 2
  s_and_b32 s34, s33, 31
  s_lshr_b32 s35, s33, 5
  s_and_b32 s35, s35, 1
  s_lshr_b32 s36, s33, 6
  s_lshr_b32 s37, s36, 2
  s_and_b32 s36, s36, 3
  s_lshl_b32 s37, s37, 5
  s_add_u32 s34, s34, s37
  s_lshl_b32 s36, s36, 3
  s_lshl_b32 s35, s35, 2
  s_add_u32 s36, s36, s35
  s_lshl_b32 s36, s36, 6
  s_add_u32 s34, s34, s36
  s_mul_i32 s34, s34, 1026
  s_add_u32 s38, s34, 0
  s_add_u32 s39, s34, 65664
  s_add_u32 s40, s34, 131328
  s_add_u32 s41, s34, 196992
  buffer_load_ushort v28, v3, s[20:23], s38 offen
  buffer_load_ushort v32, v3, s[24:27], s38 offen
  buffer_load_ushort v29, v3, s[20:23], s39 offen
  buffer_load_ushort v33, v3, s[24:27], s39 offen
  buffer_load_ushort v30, v3, s[20:23], s40 offen
  buffer_load_ushort v34, v3, s[24:27], s40 offen
  buffer_load_ushort v31, v3, s[20:23], s41 offen
  buffer_load_ushort v35, v3, s[24:27], s41 offen
  s_add_u32 s33, s31, 3
  s_and_b32 s34, s33, 31
  s_lshr_b32 s35, s33, 5
  s_and_b32 s35, s35, 1
  s_lshr_b32 s36, s33, 6
  s_lshr_b32 s37, s36, 2
  s_and_b32 s36, s36, 3
  s_lshl_b32 s37, s37, 5
  s_add_u32 s34, s34, s37
  s_lshl_b32 s36, s36, 3
  s_lshl_b32 s35, s35, 2
  s_add_u32 s36, s36, s35
  s_lshl_b32 s36, s36, 6
  s_add_u32 s34, s34, s36
  s_mul_i32 s34, s34, 1026
  s_add_u32 s38, s34, 0
  s_add_u32 s39, s34, 65664
  s_add_u32 s40, s34, 131328
  s_add_u32 s41, s34, 196992
  buffer_load_ushort v36, v3, s[20:23], s38 offen
  buffer_load_ushort v40, v3, s[24:27], s38 offen
  buffer_load_ushort v37, v3, s[20:23], s39 offen
  buffer_load_ushort v41, v3, s[24:27], s39 offen
  buffer_load_ushort v38, v3, s[20:23], s40 offen
  buffer_load_ushort v42, v3, s[24:27], s40 offen
  buffer_load_ushort v39, v3, s[20:23], s41 offen
  buffer_load_ushort v43, v3, s[24:27], s41 offen
  v_cmp_gt_u32 vcc, 513, v2
  s_nop 0
  s_and_saveexec_b64 s[44:45], vcc
  s_waitcnt vmcnt(0)
  v_lshlrev_b32 v12, 16, v12
  v_lshlrev_b32 v16, 16, v16
  v_mul_f32 v12, v12, v5
  v_mul_f32 v16, v16, v5
  v_cvt_pk_bf16_f32 v80, v12, v16
  v_lshlrev_b32 v13, 16, v13
  v_lshlrev_b32 v17, 16, v17
  v_mul_f32 v13, v13, v5
  v_mul_f32 v17, v17, v5
  v_cvt_pk_bf16_f32 v81, v13, v17
  v_lshlrev_b32 v14, 16, v14
  v_lshlrev_b32 v18, 16, v18
  v_mul_f32 v14, v14, v5
  v_mul_f32 v18, v18, v5
  v_cvt_pk_bf16_f32 v82, v14, v18
  v_lshlrev_b32 v15, 16, v15
  v_lshlrev_b32 v19, 16, v19
  v_mul_f32 v15, v15, v5
  v_mul_f32 v19, v19, v5
  v_cvt_pk_bf16_f32 v83, v15, v19
  s_lshl_b32 s33, s31, 4
  s_add_u32 s33, s33, 0xa00000
  buffer_store_dwordx4 v[80:83], v4, s[16:19], s33 offen
  v_lshlrev_b32 v20, 16, v20
  v_lshlrev_b32 v24, 16, v24
  v_mul_f32 v20, v20, v5
  v_mul_f32 v24, v24, v5
  v_cvt_pk_bf16_f32 v84, v20, v24
  v_lshlrev_b32 v21, 16, v21
  v_lshlrev_b32 v25, 16, v25
  v_mul_f32 v21, v21, v5
  v_mul_f32 v25, v25, v5
  v_cvt_pk_bf16_f32 v85, v21, v25
  v_lshlrev_b32 v22, 16, v22
  v_lshlrev_b32 v26, 16, v26
  v_mul_f32 v22, v22, v5
  v_mul_f32 v26, v26, v5
  v_cvt_pk_bf16_f32 v86, v22, v26
  v_lshlrev_b32 v23, 16, v23
  v_lshlrev_b32 v27, 16, v27
  v_mul_f32 v23, v23, v5
  v_mul_f32 v27, v27, v5
  v_cvt_pk_bf16_f32 v87, v23, v27
  s_lshl_b32 s33, s31, 4
  s_add_u32 s33, s33, 0xa00010
  buffer_store_dwordx4 v[84:87], v4, s[16:19], s33 offen
  v_lshlrev_b32 v28, 16, v28
  v_lshlrev_b32 v32, 16, v32
  v_mul_f32 v28, v28, v5
  v_mul_f32 v32, v32, v5
  v_cvt_pk_bf16_f32 v88, v28, v32
  v_lshlrev_b32 v29, 16, v29
  v_lshlrev_b32 v33, 16, v33
  v_mul_f32 v29, v29, v5
  v_mul_f32 v33, v33, v5
  v_cvt_pk_bf16_f32 v89, v29, v33
  v_lshlrev_b32 v30, 16, v30
  v_lshlrev_b32 v34, 16, v34
  v_mul_f32 v30, v30, v5
  v_mul_f32 v34, v34, v5
  v_cvt_pk_bf16_f32 v90, v30, v34
  v_lshlrev_b32 v31, 16, v31
  v_lshlrev_b32 v35, 16, v35
  v_mul_f32 v31, v31, v5
  v_mul_f32 v35, v35, v5
  v_cvt_pk_bf16_f32 v91, v31, v35
  s_lshl_b32 s33, s31, 4
  s_add_u32 s33, s33, 0xa00020
  buffer_store_dwordx4 v[88:91], v4, s[16:19], s33 offen
  v_lshlrev_b32 v36, 16, v36
  v_lshlrev_b32 v40, 16, v40
  v_mul_f32 v36, v36, v5
  v_mul_f32 v40, v40, v5
  v_cvt_pk_bf16_f32 v92, v36, v40
  v_lshlrev_b32 v37, 16, v37
  v_lshlrev_b32 v41, 16, v41
  v_mul_f32 v37, v37, v5
  v_mul_f32 v41, v41, v5
  v_cvt_pk_bf16_f32 v93, v37, v41
  v_lshlrev_b32 v38, 16, v38
  v_lshlrev_b32 v42, 16, v42
  v_mul_f32 v38, v38, v5
  v_mul_f32 v42, v42, v5
  v_cvt_pk_bf16_f32 v94, v38, v42
  v_lshlrev_b32 v39, 16, v39
  v_lshlrev_b32 v43, 16, v43
  v_mul_f32 v39, v39, v5
  v_mul_f32 v43, v43, v5
  v_cvt_pk_bf16_f32 v95, v39, v43
  s_lshl_b32 s33, s31, 4
  s_add_u32 s33, s33, 0xa00030
  buffer_store_dwordx4 v[92:95], v4, s[16:19], s33 offen
  s_branch A_done
A_tabs:
  s_sub_u32 s28, s2, 400
  v_and_b32 v2, 31, v1
  v_lshrrev_b32 v3, 5, v1
  v_lshlrev_b32 v4, 4, v1
  v_and_b32 v6, 15, v1
  v_lshrrev_b32 v7, 4, v1
  s_cmp_eq_u32 s28, 2
  s_cbranch_scc1 A_tab2
  s_lshr_b32 s29, s3, 2
  s_and_b32 s30, s3, 3
  s_lshl_b32 s31, s29, 5
  v_add_u32 v8, s31, v2
  s_lshl_b32 s32, s30, 4
  s_lshl_b32 s33, s3, 10
  s_cmp_eq_u32 s28, 1
  s_cbranch_scc1 A_tab1
  v_lshlrev_b32 v9, 3, v3
  v_add_u32 v9, s32, v9
  v_add_u32 v10, 0, v9
  v_mul_u32_u24 v10, v10, v8
  v_and_b32 v11, 63, v10
  v_cvt_f32_u32 v11, v11
  v_mul_f32 v11, 0x3c800000, v11
  v_cos_f32 v12, v11
  v_sin_f32 v20, v11
  v_add_u32 v10, 1, v9
  v_mul_u32_u24 v10, v10, v8
  v_and_b32 v11, 63, v10
  v_cvt_f32_u32 v11, v11
  v_mul_f32 v11, 0x3c800000, v11
  v_cos_f32 v13, v11
  v_sin_f32 v21, v11
  v_add_u32 v10, 2, v9
  v_mul_u32_u24 v10, v10, v8
  v_and_b32 v11, 63, v10
  v_cvt_f32_u32 v11, v11
  v_mul_f32 v11, 0x3c800000, v11
  v_cos_f32 v14, v11
  v_sin_f32 v22, v11
  v_add_u32 v10, 3, v9
  v_mul_u32_u24 v10, v10, v8
  v_and_b32 v11, 63, v10
  v_cvt_f32_u32 v11, v11
  v_mul_f32 v11, 0x3c800000, v11
  v_cos_f32 v15, v11
  v_sin_f32 v23, v11
  v_add_u32 v10, 4, v9
  v_mul_u32_u24 v10, v10, v8
  v_and_b32 v11, 63, v10
  v_cvt_f32_u32 v11, v11
  v_mul_f32 v11, 0x3c800000, v11
  v_cos_f32 v16, v11
  v_sin_f32 v24, v11
  v_add_u32 v10, 5, v9
  v_mul_u32_u24 v10, v10, v8
  v_and_b32 v11, 63, v10
  v_cvt_f32_u32 v11, v11
  v_mul_f32 v11, 0x3c800000, v11
  v_cos_f32 v17, v11
  v_sin_f32 v25, v11
  v_add_u32 v10, 6, v9
  v_mul_u32_u24 v10, v10, v8
  v_and_b32 v11, 63, v10
  v_cvt_f32_u32 v11, v11
  v_mul_f32 v11, 0x3c800000, v11
  v_cos_f32 v18, v11
  v_sin_f32 v26, v11
  v_add_u32 v10, 7, v9
  v_mul_u32_u24 v10, v10, v8
  v_and_b32 v11, 63, v10
  v_cvt_f32_u32 v11, v11
  v_mul_f32 v11, 0x3c800000, v11
  v_cos_f32 v19, v11
  v_sin_f32 v27, v11
  s_add_u32 s33, s33, 0xf00000
  v_cvt_pk_bf16_f32 v28, v12, v13
  v_cvt_pk_bf16_f32 v32, v20, v21
  v_cvt_pk_bf16_f32 v36, -v20, -v21
  v_cvt_pk_bf16_f32 v29, v14, v15
  v_cvt_pk_bf16_f32 v33, v22, v23
  v_cvt_pk_bf16_f32 v37, -v22, -v23
  v_cvt_pk_bf16_f32 v30, v16, v17
  v_cvt_pk_bf16_f32 v34, v24, v25
  v_cvt_pk_bf16_f32 v38, -v24, -v25
  v_cvt_pk_bf16_f32 v31, v18, v19
  v_cvt_pk_bf16_f32 v35, v26, v27
  v_cvt_pk_bf16_f32 v39, -v26, -v27
  s_add_u32 s40, s33, 0
  buffer_store_dwordx4 v[28:31], v4, s[16:19], s40 offen
  s_add_u32 s40, s33, 8192
  buffer_store_dwordx4 v[32:35], v4, s[16:19], s40 offen
  s_add_u32 s40, s33, 16384
  buffer_store_dwordx4 v[36:39], v4, s[16:19], s40 offen
  s_branch A_done
A_tab1:
  v_lshlrev_b32 v9, 2, v3
  v_add_u32 v9, s32, v9
  v_add_u32 v10, 0, v9
  v_mul_u32_u24 v10, v10, v8
  v_and_b32 v11, 63, v10
  v_cvt_f32_u32 v11, v11
  v_mul_f32 v11, 0x3c800000, v11
  v_cos_f32 v12, v11
  v_sin_f32 v20, v11
  v_add_u32 v10, 1, v9
  v_mul_u32_u24 v10, v10, v8
  v_and_b32 v11, 63, v10
  v_cvt_f32_u32 v11, v11
  v_mul_f32 v11, 0x3c800000, v11
  v_cos_f32 v13, v11
  v_sin_f32 v21, v11
  v_add_u32 v10, 2, v9
  v_mul_u32_u24 v10, v10, v8
  v_and_b32 v11, 63, v10
  v_cvt_f32_u32 v11, v11
  v_mul_f32 v11, 0x3c800000, v11
  v_cos_f32 v14, v11
  v_sin_f32 v22, v11
  v_add_u32 v10, 3, v9
  v_mul_u32_u24 v10, v10, v8
  v_and_b32 v11, 63, v10
  v_cvt_f32_u32 v11, v11
  v_mul_f32 v11, 0x3c800000, v11
  v_cos_f32 v15, v11
  v_sin_f32 v23, v11
  v_add_u32 v10, 8, v9
  v_mul_u32_u24 v10, v10, v8
  v_and_b32 v11, 63, v10
  v_cvt_f32_u32 v11, v11
  v_mul_f32 v11, 0x3c800000, v11
  v_cos_f32 v16, v11
  v_sin_f32 v24, v11
  v_add_u32 v10, 9, v9
  v_mul_u32_u24 v10, v10, v8
  v_and_b32 v11, 63, v10
  v_cvt_f32_u32 v11, v11
  v_mul_f32 v11, 0x3c800000, v11
  v_cos_f32 v17, v11
  v_sin_f32 v25, v11
  v_add_u32 v10, 10, v9
  v_mul_u32_u24 v10, v10, v8
  v_and_b32 v11, 63, v10
  v_cvt_f32_u32 v11, v11
  v_mul_f32 v11, 0x3c800000, v11
  v_cos_f32 v18, v11
  v_sin_f32 v26, v11
  v_add_u32 v10, 11, v9
  v_mul_u32_u24 v10, v10, v8
  v_and_b32 v11, 63, v10
  v_cvt_f32_u32 v11, v11
  v_mul_f32 v11, 0x3c800000, v11
  v_cos_f32 v19, v11
  v_sin_f32 v27, v11
  s_add_u32 s33, s33, 0xf06000
  v_cvt_pk_bf16_f32 v28, v12, v13
  v_cvt_pk_bf16_f32 v32, v20, v21
  v_cvt_pk_bf16_f32 v36, -v20, -v21
  v_cvt_pk_bf16_f32 v29, v14, v15
  v_cvt_pk_bf16_f32 v33, v22, v23
  v_cvt_pk_bf16_f32 v37, -v22, -v23
  v_cvt_pk_bf16_f32 v30, v16, v17
  v_cvt_pk_bf16_f32 v34, v24, v25
  v_cvt_pk_bf16_f32 v38, -v24, -v25
  v_cvt_pk_bf16_f32 v31, v18, v19
  v_cvt_pk_bf16_f32 v35, v26, v27
  v_cvt_pk_bf16_f32 v39, -v26, -v27
  s_add_u32 s40, s33, 0
  buffer_store_dwordx4 v[28:31], v4, s[16:19], s40 offen
  s_add_u32 s40, s33, 8192
  buffer_store_dwordx4 v[32:35], v4, s[16:19], s40 offen
  s_add_u32 s40, s33, 16384
  buffer_store_dwordx4 v[36:39], v4, s[16:19], s40 offen
  s_branch A_done
A_tab2:
  s_cmp_ge_u32 s3, 2
  s_cbranch_scc1 A_tab3
  s_lshl_b32 s32, s3, 4
  v_lshlrev_b32 v9, 2, v3
  v_add_u32 v9, s32, v9
  v_add_u32 v10, 0, v9
  v_mul_u32_u24 v10, v10, v2
  v_and_b32 v11, 31, v10
  v_cvt_f32_u32 v11, v11
  v_mul_f32 v11, 0x3d000000, v11
  v_cos_f32 v12, v11
  v_sin_f32 v20, v11
  v_add_u32 v10, 1, v9
  v_mul_u32_u24 v10, v10, v2
  v_and_b32 v11, 31, v10
  v_cvt_f32_u32 v11, v11
  v_mul_f32 v11, 0x3d000000, v11
  v_cos_f32 v13, v11
  v_sin_f32 v21, v11
  v_add_u32 v10, 2, v9
  v_mul_u32_u24 v10, v10, v2
  v_and_b32 v11, 31, v10
  v_cvt_f32_u32 v11, v11
  v_mul_f32 v11, 0x3d000000, v11
  v_cos_f32 v14, v11
  v_sin_f32 v22, v11
  v_add_u32 v10, 3, v9
  v_mul_u32_u24 v10, v10, v2
  v_and_b32 v11, 31, v10
  v_cvt_f32_u32 v11, v11
  v_mul_f32 v11, 0x3d000000, v11
  v_cos_f32 v15, v11
  v_sin_f32 v23, v11
  v_add_u32 v10, 8, v9
  v_mul_u32_u24 v10, v10, v2
  v_and_b32 v11, 31, v10
  v_cvt_f32_u32 v11, v11
  v_mul_f32 v11, 0x3d000000, v11
  v_cos_f32 v16, v11
  v_sin_f32 v24, v11
  v_add_u32 v10, 9, v9
  v_mul_u32_u24 v10, v10, v2
  v_and_b32 v11, 31, v10
  v_cvt_f32_u32 v11, v11
  v_mul_f32 v11, 0x3d000000, v11
  v_cos_f32 v17, v11
  v_sin_f32 v25, v11
  v_add_u32 v10, 10, v9
  v_mul_u32_u24 v10, v10, v2
  v_and_b32 v11, 31, v10
  v_cvt_f32_u32 v11, v11
  v_mul_f32 v11, 0x3d000000, v11
  v_cos_f32 v18, v11
  v_sin_f32 v26, v11
  v_add_u32 v10, 11, v9
  v_mul_u32_u24 v10, v10, v2
  v_and_b32 v11, 31, v10
  v_cvt_f32_u32 v11, v11
  v_mul_f32 v11, 0x3d000000, v11
  v_cos_f32 v19, v11
  v_sin_f32 v27, v11
  s_lshl_b32 s33, s3, 10
  s_add_u32 s33, s33, 0xf0c000
  v_cvt_pk_bf16_f32 v28, v12, v13
  v_cvt_pk_bf16_f32 v32, v20, v21
  v_cvt_pk_bf16_f32 v36, -v20, -v21
  v_cvt_pk_bf16_f32 v29, v14, v15
  v_cvt_pk_bf16_f32 v33, v22, v23
  v_cvt_pk_bf16_f32 v37, -v22, -v23
  v_cvt_pk_bf16_f32 v30, v16, v17
  v_cvt_pk_bf16_f32 v34, v24, v25
  v_cvt_pk_bf16_f32 v38, -v24, -v25
  v_cvt_pk_bf16_f32 v31, v18, v19
  v_cvt_pk_bf16_f32 v35, v26, v27
  v_cvt_pk_bf16_f32 v39, -v26, -v27
  s_add_u32 s40, s33, 0
  buffer_store_dwordx4 v[28:31], v4, s[16:19], s40 offen
  s_add_u32 s40, s33, 2048
  buffer_store_dwordx4 v[32:35], v4, s[16:19], s40 offen
  s_add_u32 s40, s33, 4096
  buffer_store_dwordx4 v[36:39], v4, s[16:19], s40 offen
  s_branch A_done
A_tab3:
  s_cmp_ge_u32 s3, 6
  s_cbranch_scc1 A_tab4
  s_and_b32 s29, s3, 1
  s_lshl_b32 s31, s29, 5
  v_lshlrev_b32 v9, 2, v3
  v_mov_b32 v8, v2
  s_cmp_ge_u32 s3, 4
  s_cbranch_scc1 A_tw2
  v_add_u32 v8, s31, v8
  s_branch A_twc
A_tw2:
  v_add_u32 v9, s31, v9
A_twc:
  s_sub_u32 s33, s3, 2
  s_lshl_b32 s33, s33, 13
  s_add_u32 s33, s33, 0xf0e000
  v_add_u32 v10, 0, v9
  v_mul_u32_u24 v10, v10, v8
  v_cvt_f32_u32 v11, v10
  v_mul_f32 v11, 0x3a000000, v11
  v_cos_f32 v28, v11
  v_sin_f32 v30, v11
  v_add_u32 v10, 1, v9
  v_mul_u32_u24 v10, v10, v8
  v_cvt_f32_u32 v11, v10
  v_mul_f32 v11, 0x3a000000, v11
  v_cos_f32 v29, v11
  v_sin_f32 v31, v11
  s_add_u32 s40, s33, 0
  buffer_store_dwordx4 v[28:31], v4, s[16:19], s40 offen
  v_add_u32 v10, 2, v9
  v_mul_u32_u24 v10, v10, v8
  v_cvt_f32_u32 v11, v10
  v_mul_f32 v11, 0x3a000000, v11
  v_cos_f32 v28, v11
  v_sin_f32 v30, v11
  v_add_u32 v10, 3, v9
  v_mul_u32_u24 v10, v10, v8
  v_cvt_f32_u32 v11, v10
  v_mul_f32 v11, 0x3a000000, v11
  v_cos_f32 v29, v11
  v_sin_f32 v31, v11
  s_add_u32 s40, s33, 1024
  buffer_store_dwordx4 v[28:31], v4, s[16:19], s40 offen
  v_add_u32 v10, 8, v9
  v_mul_u32_u24 v10, v10, v8
  v_cvt_f32_u32 v11, v10
  v_mul_f32 v11, 0x3a000000, v11
  v_cos_f32 v28, v11
  v_sin_f32 v30, v11
  v_add_u32 v10, 9, v9
  v_mul_u32_u24 v10, v10, v8
  v_cvt_f32_u32 v11, v10
  v_mul_f32 v11, 0x3a000000, v11
  v_cos_f32 v29, v11
  v_sin_f32 v31, v11
  s_add_u32 s40, s33, 2048
  buffer_store_dwordx4 v[28:31], v4, s[16:19], s40 offen
  v_add_u32 v10, 10, v9
  v_mul_u32_u24 v10, v10, v8
  v_cvt_f32_u32 v11, v10
  v_mul_f32 v11, 0x3a000000, v11
  v_cos_f32 v28, v11
  v_sin_f32 v30, v11
  v_add_u32 v10, 11, v9
  v_mul_u32_u24 v10, v10, v8
  v_cvt_f32_u32 v11, v10
  v_mul_f32 v11, 0x3a000000, v11
  v_cos_f32 v29, v11
  v_sin_f32 v31, v11
  s_add_u32 s40, s33, 3072
  buffer_store_dwordx4 v[28:31], v4, s[16:19], s40 offen
  v_add_u32 v10, 16, v9
  v_mul_u32_u24 v10, v10, v8
  v_cvt_f32_u32 v11, v10
  v_mul_f32 v11, 0x3a000000, v11
  v_cos_f32 v28, v11
  v_sin_f32 v30, v11
  v_add_u32 v10, 17, v9
  v_mul_u32_u24 v10, v10, v8
  v_cvt_f32_u32 v11, v10
  v_mul_f32 v11, 0x3a000000, v11
  v_cos_f32 v29, v11
  v_sin_f32 v31, v11
  s_add_u32 s40, s33, 4096
  buffer_store_dwordx4 v[28:31], v4, s[16:19], s40 offen
  v_add_u32 v10, 18, v9
  v_mul_u32_u24 v10, v10, v8
  v_cvt_f32_u32 v11, v10
  v_mul_f32 v11, 0x3a000000, v11
  v_cos_f32 v28, v11
  v_sin_f32 v30, v11
  v_add_u32 v10, 19, v9
  v_mul_u32_u24 v10, v10, v8
  v_cvt_f32_u32 v11, v10
  v_mul_f32 v11, 0x3a000000, v11
  v_cos_f32 v29, v11
  v_sin_f32 v31, v11
  s_add_u32 s40, s33, 5120
  buffer_store_dwordx4 v[28:31], v4, s[16:19], s40 offen
  v_add_u32 v10, 24, v9
  v_mul_u32_u24 v10, v10, v8
  v_cvt_f32_u32 v11, v10
  v_mul_f32 v11, 0x3a000000, v11
  v_cos_f32 v28, v11
  v_sin_f32 v30, v11
  v_add_u32 v10, 25, v9
  v_mul_u32_u24 v10, v10, v8
  v_cvt_f32_u32 v11, v10
  v_mul_f32 v11, 0x3a000000, v11
  v_cos_f32 v29, v11
  v_sin_f32 v31, v11
  s_add_u32 s40, s33, 6144
  buffer_store_dwordx4 v[28:31], v4, s[16:19], s40 offen
  v_add_u32 v10, 26, v9
  v_mul_u32_u24 v10, v10, v8
  v_cvt_f32_u32 v11, v10
  v_mul_f32 v11, 0x3a000000, v11
  v_cos_f32 v28, v11
  v_sin_f32 v30, v11
  v_add_u32 v10, 27, v9
  v_mul_u32_u24 v10, v10, v8
  v_cvt_f32_u32 v11, v10
  v_mul_f32 v11, 0x3a000000, v11
  v_cos_f32 v29, v11
  v_sin_f32 v31, v11
  s_add_u32 s40, s33, 7168
  buffer_store_dwordx4 v[28:31], v4, s[16:19], s40 offen
  s_branch A_done
A_tab4:
  v_lshlrev_b32 v9, 2, v7
  s_cmp_eq_u32 s3, 7
  s_cbranch_scc1 A_tab5
  v_add_u32 v8, 0, v6
  v_add_u32 v10, 0, v9
  v_mul_u32_u24 v10, v10, v8
  v_and_b32 v11, 31, v10
  v_cvt_f32_u32 v11, v11
  v_mul_f32 v11, 0x3d000000, v11
  v_cos_f32 v12, v11
  v_sin_f32 v20, v11
  v_add_u32 v10, 1, v9
  v_mul_u32_u24 v10, v10, v8
  v_and_b32 v11, 31, v10
  v_cvt_f32_u32 v11, v11
  v_mul_f32 v11, 0x3d000000, v11
  v_cos_f32 v13, v11
  v_sin_f32 v21, v11
  v_add_u32 v10, 2, v9
  v_mul_u32_u24 v10, v10, v8
  v_and_b32 v11, 31, v10
  v_cvt_f32_u32 v11, v11
  v_mul_f32 v11, 0x3d000000, v11
  v_cos_f32 v14, v11
  v_sin_f32 v22, v11
  v_add_u32 v10, 3, v9
  v_mul_u32_u24 v10, v10, v8
  v_and_b32 v11, 31, v10
  v_cvt_f32_u32 v11, v11
  v_mul_f32 v11, 0x3d000000, v11
  v_cos_f32 v15, v11
  v_sin_f32 v23, v11
  v_cvt_pk_bf16_f32 v28, v12, v13
  v_cvt_pk_bf16_f32 v29, v14, v15
  v_cvt_pk_bf16_f32 v30, -v20, -v21
  v_cvt_pk_bf16_f32 v31, -v22, -v23
  v_cvt_pk_bf16_f32 v32, v20, v21
  v_cvt_pk_bf16_f32 v33, v22, v23
  v_cvt_pk_bf16_f32 v34, v12, v13
  v_cvt_pk_bf16_f32 v35, v14, v15
  s_mov_b32 s40, 0xf16000
  buffer_store_dwordx4 v[28:31], v4, s[16:19], s40 offen
  s_mov_b32 s40, 0xf16800
  buffer_store_dwordx4 v[32:35], v4, s[16:19], s40 offen
  v_add_u32 v10, 0, v9
  v_mul_u32_u24 v10, v10, v8
  v_and_b32 v11, 31, v10
  v_cvt_f32_u32 v11, v11
  v_mul_f32 v11, 0x3d000000, v11
  v_cos_f32 v12, v11
  v_sin_f32 v20, v11
  v_add_u32 v10, 1, v9
  v_mul_u32_u24 v10, v10, v8
  v_and_b32 v11, 31, v10
  v_cvt_f32_u32 v11, v11
  v_mul_f32 v11, 0x3d000000, v11
  v_cos_f32 v13, v11
  v_sin_f32 v21, v11
  v_add_u32 v10, 2, v9
  v_mul_u32_u24 v10, v10, v8
  v_and_b32 v11, 31, v10
  v_cvt_f32_u32 v11, v11
  v_mul_f32 v11, 0x3d000000, v11
  v_cos_f32 v14, v11
  v_sin_f32 v22, v11
  v_add_u32 v10, 3, v9
  v_mul_u32_u24 v10, v10, v8
  v_and_b32 v11, 31, v10
  v_cvt_f32_u32 v11, v11
  v_mul_f32 v11, 0x3d000000, v11
  v_cos_f32 v15, v11
  v_sin_f32 v23, v11
  v_add_u32 v10, 16, v9
  v_mul_u32_u24 v10, v10, v8
  v_and_b32 v11, 31, v10
  v_cvt_f32_u32 v11, v11
  v_mul_f32 v11, 0x3d000000, v11
  v_cos_f32 v16, v11
  v_sin_f32 v24, v11
  v_add_u32 v10, 17, v9
  v_mul_u32_u24 v10, v10, v8
  v_and_b32 v11, 31, v10
  v_cvt_f32_u32 v11, v11
  v_mul_f32 v11, 0x3d000000, v11
  v_cos_f32 v17, v11
  v_sin_f32 v25, v11
  v_add_u32 v10, 18, v9
  v_mul_u32_u24 v10, v10, v8
  v_and_b32 v11, 31, v10
  v_cvt_f32_u32 v11, v11
  v_mul_f32 v11, 0x3d000000, v11
  v_cos_f32 v18, v11
  v_sin_f32 v26, v11
  v_add_u32 v10, 19, v9
  v_mul_u32_u24 v10, v10, v8
  v_and_b32 v11, 31, v10
  v_cvt_f32_u32 v11, v11
  v_mul_f32 v11, 0x3d000000, v11
  v_cos_f32 v19, v11
  v_sin_f32 v27, v11
  v_cvt_pk_bf16_f32 v36, v12, v13
  v_cvt_pk_bf16_f32 v40, -v20, -v21
  v_cvt_pk_bf16_f32 v37, v14, v15
  v_cvt_pk_bf16_f32 v41, -v22, -v23
  v_cvt_pk_bf16_f32 v38, v16, v17
  v_cvt_pk_bf16_f32 v42, -v24, -v25
  v_cvt_pk_bf16_f32 v39, v18, v19
  v_cvt_pk_bf16_f32 v43, -v26, -v27
  s_mov_b32 s40, 0xf19000
  buffer_store_dwordx4 v[36:39], v4, s[16:19], s40 offen
  s_mov_b32 s40, 0xf19800
  buffer_store_dwordx4 v[40:43], v4, s[16:19], s40 offen
  v_add_u32 v8, 16, v6
  v_add_u32 v10, 0, v9
  v_mul_u32_u24 v10, v10, v8
  v_and_b32 v11, 31, v10
  v_cvt_f32_u32 v11, v11
  v_mul_f32 v11, 0x3d000000, v11
  v_cos_f32 v12, v11
  v_sin_f32 v20, v11
  v_add_u32 v10, 1, v9
  v_mul_u32_u24 v10, v10, v8
  v_and_b32 v11, 31, v10
  v_cvt_f32_u32 v11, v11
  v_mul_f32 v11, 0x3d000000, v11
  v_cos_f32 v13, v11
  v_sin_f32 v21, v11
  v_add_u32 v10, 2, v9
  v_mul_u32_u24 v10, v10, v8
  v_and_b32 v11, 31, v10
  v_cvt_f32_u32 v11, v11
  v_mul_f32 v11, 0x3d000000, v11
  v_cos_f32 v14, v11
  v_sin_f32 v22, v11
  v_add_u32 v10, 3, v9
  v_mul_u32_u24 v10, v10, v8
  v_and_b32 v11, 31, v10
  v_cvt_f32_u32 v11, v11
  v_mul_f32 v11, 0x3d000000, v11
  v_cos_f32 v15, v11
  v_sin_f32 v23, v11
  v_cvt_pk_bf16_f32 v28, v12, v13
  v_cvt_pk_bf16_f32 v29, v14, v15
  v_cvt_pk_bf16_f32 v30, -v20, -v21
  v_cvt_pk_bf16_f32 v31, -v22, -v23
  v_cvt_pk_bf16_f32 v32, v20, v21
  v_cvt_pk_bf16_f32 v33, v22, v23
  v_cvt_pk_bf16_f32 v34, v12, v13
  v_cvt_pk_bf16_f32 v35, v14, v15
  s_mov_b32 s40, 0xf16400
  buffer_store_dwordx4 v[28:31], v4, s[16:19], s40 offen
  s_mov_b32 s40, 0xf16c00
  buffer_store_dwordx4 v[32:35], v4, s[16:19], s40 offen
  v_add_u32 v10, 0, v9
  v_mul_u32_u24 v10, v10, v8
  v_and_b32 v11, 31, v10
  v_cvt_f32_u32 v11, v11
  v_mul_f32 v11, 0x3d000000, v11
  v_cos_f32 v12, v11
  v_sin_f32 v20, v11
  v_add_u32 v10, 1, v9
  v_mul_u32_u24 v10, v10, v8
  v_and_b32 v11, 31, v10
  v_cvt_f32_u32 v11, v11
  v_mul_f32 v11, 0x3d000000, v11
  v_cos_f32 v13, v11
  v_sin_f32 v21, v11
  v_add_u32 v10, 2, v9
  v_mul_u32_u24 v10, v10, v8
  v_and_b32 v11, 31, v10
  v_cvt_f32_u32 v11, v11
  v_mul_f32 v11, 0x3d000000, v11
  v_cos_f32 v14, v11
  v_sin_f32 v22, v11
  v_add_u32 v10, 3, v9
  v_mul_u32_u24 v10, v10, v8
  v_and_b32 v11, 31, v10
  v_cvt_f32_u32 v11, v11
  v_mul_f32 v11, 0x3d000000, v11
  v_cos_f32 v15, v11
  v_sin_f32 v23, v11
  v_add_u32 v10, 16, v9
  v_mul_u32_u24 v10, v10, v8
  v_and_b32 v11, 31, v10
  v_cvt_f32_u32 v11, v11
  v_mul_f32 v11, 0x3d000000, v11
  v_cos_f32 v16, v11
  v_sin_f32 v24, v11
  v_add_u32 v10, 17, v9
  v_mul_u32_u24 v10, v10, v8
  v_and_b32 v11, 31, v10
  v_cvt_f32_u32 v11, v11
  v_mul_f32 v11, 0x3d000000, v11
  v_cos_f32 v17, v11
  v_sin_f32 v25, v11
  v_add_u32 v10, 18, v9
  v_mul_u32_u24 v10, v10, v8
  v_and_b32 v11, 31, v10
  v_cvt_f32_u32 v11, v11
  v_mul_f32 v11, 0x3d000000, v11
  v_cos_f32 v18, v11
  v_sin_f32 v26, v11
  v_add_u32 v10, 19, v9
  v_mul_u32_u24 v10, v10, v8
  v_and_b32 v11, 31, v10
  v_cvt_f32_u32 v11, v11
  v_mul_f32 v11, 0x3d000000, v11
  v_cos_f32 v19, v11
  v_sin_f32 v27, v11
  v_cvt_pk_bf16_f32 v36, v12, v13
  v_cvt_pk_bf16_f32 v40, -v20, -v21
  v_cvt_pk_bf16_f32 v37, v14, v15
  v_cvt_pk_bf16_f32 v41, -v22, -v23
  v_cvt_pk_bf16_f32 v38, v16, v17
  v_cvt_pk_bf16_f32 v42, -v24, -v25
  v_cvt_pk_bf16_f32 v39, v18, v19
  v_cvt_pk_bf16_f32 v43, -v26, -v27
  s_mov_b32 s40, 0xf19400
  buffer_store_dwordx4 v[36:39], v4, s[16:19], s40 offen
  s_mov_b32 s40, 0xf19c00
  buffer_store_dwordx4 v[40:43], v4, s[16:19], s40 offen
  s_branch A_done
A_tab5:
  v_add_u32 v8, 0, v6
  v_add_u32 v10, 0, v9
  v_mul_u32_u24 v10, v10, v8
  v_cvt_f32_u32 v11, v10
  v_mul_f32 v11, 0x3a800000, v11
  v_cos_f32 v28, v11
  v_sin_f32 v30, v11
  v_add_u32 v10, 1, v9
  v_mul_u32_u24 v10, v10, v8
  v_cvt_f32_u32 v11, v10
  v_mul_f32 v11, 0x3a800000, v11
  v_cos_f32 v29, v11
  v_sin_f32 v31, v11
  s_mov_b32 s40, 0xf17000
  buffer_store_dwordx4 v[28:31], v4, s[16:19], s40 offen
  v_add_u32 v10, 2, v9
  v_mul_u32_u24 v10, v10, v8
  v_cvt_f32_u32 v11, v10
  v_mul_f32 v11, 0x3a800000, v11
  v_cos_f32 v28, v11
  v_sin_f32 v30, v11
  v_add_u32 v10, 3, v9
  v_mul_u32_u24 v10, v10, v8
  v_cvt_f32_u32 v11, v10
  v_mul_f32 v11, 0x3a800000, v11
  v_cos_f32 v29, v11
  v_sin_f32 v31, v11
  s_mov_b32 s40, 0xf17400
  buffer_store_dwordx4 v[28:31], v4, s[16:19], s40 offen
  v_add_u32 v8, 16, v6
  v_add_u32 v10, 0, v9
  v_mul_u32_u24 v10, v10, v8
  v_cvt_f32_u32 v11, v10
  v_mul_f32 v11, 0x3a800000, v11
  v_cos_f32 v28, v11
  v_sin_f32 v30, v11
  v_add_u32 v10, 1, v9
  v_mul_u32_u24 v10, v10, v8
  v_cvt_f32_u32 v11, v10
  v_mul_f32 v11, 0x3a800000, v11
  v_cos_f32 v29, v11
  v_sin_f32 v31, v11
  s_mov_b32 s40, 0xf17800
  buffer_store_dwordx4 v[28:31], v4, s[16:19], s40 offen
  v_add_u32 v10, 2, v9
  v_mul_u32_u24 v10, v10, v8
  v_cvt_f32_u32 v11, v10
  v_mul_f32 v11, 0x3a800000, v11
  v_cos_f32 v28, v11
  v_sin_f32 v30, v11
  v_add_u32 v10, 3, v9
  v_mul_u32_u24 v10, v10, v8
  v_cvt_f32_u32 v11, v10
  v_mul_f32 v11, 0x3a800000, v11
  v_cos_f32 v29, v11
  v_sin_f32 v31, v11
  s_mov_b32 s40, 0xf17c00
  buffer_store_dwordx4 v[28:31], v4, s[16:19], s40 offen
  v_add_u32 v8, 0, v6
  v_add_u32 v10, 16, v9
  v_mul_u32_u24 v10, v10, v8
  v_cvt_f32_u32 v11, v10
  v_mul_f32 v11, 0x3a800000, v11
  v_cos_f32 v28, v11
  v_sin_f32 v30, v11
  v_add_u32 v10, 17, v9
  v_mul_u32_u24 v10, v10, v8
  v_cvt_f32_u32 v11, v10
  v_mul_f32 v11, 0x3a800000, v11
  v_cos_f32 v29, v11
  v_sin_f32 v31, v11
  s_mov_b32 s40, 0xf18000
  buffer_store_dwordx4 v[28:31], v4, s[16:19], s40 offen
  v_add_u32 v10, 18, v9
  v_mul_u32_u24 v10, v10, v8
  v_cvt_f32_u32 v11, v10
  v_mul_f32 v11, 0x3a800000, v11
  v_cos_f32 v28, v11
  v_sin_f32 v30, v11
  v_add_u32 v10, 19, v9
  v_mul_u32_u24 v10, v10, v8
  v_cvt_f32_u32 v11, v10
  v_mul_f32 v11, 0x3a800000, v11
  v_cos_f32 v29, v11
  v_sin_f32 v31, v11
  s_mov_b32 s40, 0xf18400
  buffer_store_dwordx4 v[28:31], v4, s[16:19], s40 offen
  v_add_u32 v8, 16, v6
  v_add_u32 v10, 16, v9
  v_mul_u32_u24 v10, v10, v8
  v_cvt_f32_u32 v11, v10
  v_mul_f32 v11, 0x3a800000, v11
  v_cos_f32 v28, v11
  v_sin_f32 v30, v11
  v_add_u32 v10, 17, v9
  v_mul_u32_u24 v10, v10, v8
  v_cvt_f32_u32 v11, v10
  v_mul_f32 v11, 0x3a800000, v11
  v_cos_f32 v29, v11
  v_sin_f32 v31, v11
  s_mov_b32 s40, 0xf18800
  buffer_store_dwordx4 v[28:31], v4, s[16:19], s40 offen
  v_add_u32 v10, 18, v9
  v_mul_u32_u24 v10, v10, v8
  v_cvt_f32_u32 v11, v10
  v_mul_f32 v11, 0x3a800000, v11
  v_cos_f32 v28, v11
  v_sin_f32 v30, v11
  v_add_u32 v10, 19, v9
  v_mul_u32_u24 v10, v10, v8
  v_cvt_f32_u32 v11, v10
  v_mul_f32 v11, 0x3a800000, v11
  v_cos_f32 v29, v11
  v_sin_f32 v31, v11
  s_mov_b32 s40, 0xf18c00
  buffer_store_dwordx4 v[28:31], v4, s[16:19], s40 offen
  s_branch A_done
A_pref:
  s_cmp_ge_u32 s2, 467
  s_cbranch_scc1 A_pref2
  s_load_dwordx2 s[4:5], s[0:1], 48
  v_and_b32 v1, 63, v0
  v_lshrrev_b32 v5, 6, v0
  s_nop 0
  v_readfirstlane_b32 s3, v5
  s_waitcnt lgkmcnt(0)
  s_mov_b32 s12, s4
  s_and_b32 s13, s5, 0xffff
  s_mov_b32 s14, 0x700000
  s_mov_b32 s15, 0x00020000
  s_sub_u32 s25, s2, 403
  s_mul_i32 s26, s25, 8
  s_add_u32 s26, s26, s3
  s_mul_i32 s26, s26, 14336
  v_lshlrev_b32 v2, 4, v1
  buffer_load_dwordx4 v[8:11], v2, s[12:15], s26 offen offset:0
  buffer_load_dwordx4 v[8:11], v2, s[12:15], s26 offen offset:1024
  buffer_load_dwordx4 v[8:11], v2, s[12:15], s26 offen offset:2048
  buffer_load_dwordx4 v[8:11], v2, s[12:15], s26 offen offset:3072
  s_add_u32 s26, s26, 4096
  buffer_load_dwordx4 v[8:11], v2, s[12:15], s26 offen offset:0
  buffer_load_dwordx4 v[8:11], v2, s[12:15], s26 offen offset:1024
  buffer_load_dwordx4 v[8:11], v2, s[12:15], s26 offen offset:2048
  buffer_load_dwordx4 v[8:11], v2, s[12:15], s26 offen offset:3072
  s_add_u32 s26, s26, 4096
  buffer_load_dwordx4 v[8:11], v2, s[12:15], s26 offen offset:0
  buffer_load_dwordx4 v[8:11], v2, s[12:15], s26 offen offset:1024
  buffer_load_dwordx4 v[8:11], v2, s[12:15], s26 offen offset:2048
  buffer_load_dwordx4 v[8:11], v2, s[12:15], s26 offen offset:3072
  s_add_u32 s26, s26, 4096
  buffer_load_dwordx4 v[8:11], v2, s[12:15], s26 offen offset:0
  buffer_load_dwordx4 v[8:11], v2, s[12:15], s26 offen offset:1024
  s_waitcnt vmcnt(0)
  s_branch A_done
A_pref2:
  s_load_dwordx2 s[4:5], s[0:1], 40
  v_and_b32 v1, 63, v0
  v_lshrrev_b32 v5, 6, v0
  s_nop 0
  v_readfirstlane_b32 s3, v5
  s_waitcnt lgkmcnt(0)
  s_mov_b32 s12, s4
  s_and_b32 s13, s5, 0xffff
  s_mov_b32 s14, 0x700000
  s_mov_b32 s15, 0x00020000
  s_sub_u32 s25, s2, 467
  s_and_b32 s24, s2, 7
  s_lshr_b32 s26, s25, 3
  s_mul_i32 s26, s26, 8
  s_add_u32 s26, s26, s3
  s_mul_i32 s26, s26, 114688
  s_mul_i32 s27, s24, 896
  s_add_u32 s26, s26, s27
  v_min_u32 v2, 55, v1
  v_lshlrev_b32 v2, 4, v2
  buffer_load_dwordx4 v[8:11], v2, s[12:15], s26 offen
  s_add_u32 s26, s26, 7168
  buffer_load_dwordx4 v[8:11], v2, s[12:15], s26 offen
  s_add_u32 s26, s26, 7168
  buffer_load_dwordx4 v[8:11], v2, s[12:15], s26 offen
  s_add_u32 s26, s26, 7168
  buffer_load_dwordx4 v[8:11], v2, s[12:15], s26 offen
  s_add_u32 s26, s26, 7168
  buffer_load_dwordx4 v[8:11], v2, s[12:15], s26 offen
  s_add_u32 s26, s26, 7168
  buffer_load_dwordx4 v[8:11], v2, s[12:15], s26 offen
  s_add_u32 s26, s26, 7168
  buffer_load_dwordx4 v[8:11], v2, s[12:15], s26 offen
  s_add_u32 s26, s26, 7168
  buffer_load_dwordx4 v[8:11], v2, s[12:15], s26 offen
  s_add_u32 s26, s26, 7168
  buffer_load_dwordx4 v[8:11], v2, s[12:15], s26 offen
  s_add_u32 s26, s26, 7168
  buffer_load_dwordx4 v[8:11], v2, s[12:15], s26 offen
  s_add_u32 s26, s26, 7168
  buffer_load_dwordx4 v[8:11], v2, s[12:15], s26 offen
  s_add_u32 s26, s26, 7168
  buffer_load_dwordx4 v[8:11], v2, s[12:15], s26 offen
  s_add_u32 s26, s26, 7168
  buffer_load_dwordx4 v[8:11], v2, s[12:15], s26 offen
  s_add_u32 s26, s26, 7168
  buffer_load_dwordx4 v[8:11], v2, s[12:15], s26 offen
  s_add_u32 s26, s26, 7168
  buffer_load_dwordx4 v[8:11], v2, s[12:15], s26 offen
  s_add_u32 s26, s26, 7168
  buffer_load_dwordx4 v[8:11], v2, s[12:15], s26 offen
  s_add_u32 s26, s26, 7168
  s_waitcnt vmcnt(0)
A_done:
A_done2:
  s_endpgm
.globl fftB_kernel
.p2align 8
.type fftB_kernel,@function
fftB_kernel:
  s_cmp_ge_u32 s2, 193
  s_cbranch_scc1 B_done
  s_cmp_ge_u32 s2, 129
  s_cbranch_scc1 B_pref
  s_load_dwordx2 s[10:11], s[0:1], 72
  v_and_b32 v1, 63, v0
  v_lshrrev_b32 v5, 6, v0
  s_nop 0
  v_readfirstlane_b32 s3, v5
  v_and_b32 v2, 31, v1
  v_lshrrev_b32 v3, 5, v1
  v_lshlrev_b32 v4, 4, v1
  s_waitcnt lgkmcnt(0)
  s_mov_b32 s16, s10
  s_and_b32 s17, s11, 0xffff
  s_mov_b32 s18, 0x10000000
  s_mov_b32 s19, 0x00020000
  s_mul_i32 s24, s3, 22528
  s_add_u32 s25, s24, 0xf00000
  s_mov_b32 m0, s24
  s_nop 0
  buffer_load_dwordx4 v4, s[16:19], s25 offen lds
  s_add_u32 s24, s24, 1024
  s_add_u32 s25, s25, 1024
  s_mov_b32 m0, s24
  s_nop 0
  buffer_load_dwordx4 v4, s[16:19], s25 offen lds
  s_add_u32 s24, s24, 1024
  s_add_u32 s25, s25, 1024
  s_mov_b32 m0, s24
  s_nop 0
  buffer_load_dwordx4 v4, s[16:19], s25 offen lds
  s_add_u32 s24, s24, 1024
  s_add_u32 s25, s25, 1024
  s_mov_b32 m0, s24
  s_nop 0
  buffer_load_dwordx4 v4, s[16:19], s25 offen lds
  s_add_u32 s24, s24, 1024
  s_add_u32 s25, s25, 1024
  s_mov_b32 m0, s24
  s_nop 0
  buffer_load_dwordx4 v4, s[16:19], s25 offen lds
  s_add_u32 s24, s24, 1024
  s_add_u32 s25, s25, 1024
  s_mov_b32 m0, s24
  s_nop 0
  buffer_load_dwordx4 v4, s[16:19], s25 offen lds
  s_add_u32 s24, s24, 1024
  s_add_u32 s25, s25, 1024
  s_mov_b32 m0, s24
  s_nop 0
  buffer_load_dwordx4 v4, s[16:19], s25 offen lds
  s_add_u32 s24, s24, 1024
  s_add_u32 s25, s25, 1024
  s_mov_b32 m0, s24
  s_nop 0
  buffer_load_dwordx4 v4, s[16:19], s25 offen lds
  s_add_u32 s24, s24, 1024
  s_add_u32 s25, s25, 1024
  s_mov_b32 m0, s24
  s_nop 0
  buffer_load_dwordx4 v4, s[16:19], s25 offen lds
  s_add_u32 s24, s24, 1024
  s_add_u32 s25, s25, 1024
  s_mov_b32 m0, s24
  s_nop 0
  buffer_load_dwordx4 v4, s[16:19], s25 offen lds
  s_add_u32 s24, s24, 1024
  s_add_u32 s25, s25, 1024
  s_mov_b32 m0, s24
  s_nop 0
  buffer_load_dwordx4 v4, s[16:19], s25 offen lds
  s_add_u32 s24, s24, 1024
  s_add_u32 s25, s25, 1024
  s_mov_b32 m0, s24
  s_nop 0
  buffer_load_dwordx4 v4, s[16:19], s25 offen lds
  s_add_u32 s24, s24, 1024
  s_add_u32 s25, s25, 1024
  s_mov_b32 m0, s24
  s_nop 0
  buffer_load_dwordx4 v4, s[16:19], s25 offen lds
  s_add_u32 s24, s24, 1024
  s_add_u32 s25, s25, 1024
  s_mov_b32 m0, s24
  s_nop 0
  buffer_load_dwordx4 v4, s[16:19], s25 offen lds
  s_add_u32 s24, s24, 1024
  s_add_u32 s25, s25, 1024
  s_mov_b32 m0, s24
  s_nop 0
  buffer_load_dwordx4 v4, s[16:19], s25 offen lds
  s_add_u32 s24, s24, 1024
  s_add_u32 s25, s25, 1024
  s_mov_b32 m0, s24
  s_nop 0
  buffer_load_dwordx4 v4, s[16:19], s25 offen lds
  s_add_u32 s24, s24, 1024
  s_add_u32 s25, s25, 1024
  s_mov_b32 m0, s24
  s_nop 0
  buffer_load_dwordx4 v4, s[16:19], s25 offen lds
  s_add_u32 s24, s24, 1024
  s_add_u32 s25, s25, 1024
  s_mov_b32 m0, s24
  s_nop 0
  buffer_load_dwordx4 v4, s[16:19], s25 offen lds
  s_add_u32 s24, s24, 1024
  s_add_u32 s25, s25, 1024
  s_mov_b32 m0, s24
  s_nop 0
  buffer_load_dwordx4 v4, s[16:19], s25 offen lds
  s_add_u32 s24, s24, 1024
  s_add_u32 s25, s25, 1024
  s_mov_b32 m0, s24
  s_nop 0
  buffer_load_dwordx4 v4, s[16:19], s25 offen lds
  s_add_u32 s24, s24, 1024
  s_add_u32 s25, s25, 1024
  s_mov_b32 m0, s24
  s_nop 0
  buffer_load_dwordx4 v4, s[16:19], s25 offen lds
  s_add_u32 s24, s24, 1024
  s_add_u32 s25, s25, 1024
  s_mov_b32 m0, s24
  s_nop 0
  buffer_load_dwordx4 v4, s[16:19], s25 offen lds
  s_add_u32 s24, s24, 1024
  s_add_u32 s25, s25, 1024
  s_and_b32 s20, s2, 31
  s_lshr_b32 s21, s2, 5
  s_lshl_b32 s22, s21, 2
  s_add_u32 s22, s22, s3
  s_lshl_b32 s22, s22, 5
  s_add_u32 s22, s22, s20
  s_min_u32 s23, s22, 512
  s_lshl_b32 s23, s23, 13
  v_lshlrev_b32 v5, 8, v2
  v_lshl_add_u32 v5, v3, 5, v5
  s_add_u32 s24, s23, 0x0
  buffer_load_dwordx4 v[8:11], v5, s[16:19], s24 offen offset:0
  buffer_load_dwordx4 v[24:27], v5, s[16:19], s24 offen offset:16
  buffer_load_dwordx4 v[12:15], v5, s[16:19], s24 offen offset:64
  buffer_load_dwordx4 v[28:31], v5, s[16:19], s24 offen offset:80
  buffer_load_dwordx4 v[16:19], v5, s[16:19], s24 offen offset:128
  buffer_load_dwordx4 v[32:35], v5, s[16:19], s24 offen offset:144
  buffer_load_dwordx4 v[20:23], v5, s[16:19], s24 offen offset:192
  buffer_load_dwordx4 v[36:39], v5, s[16:19], s24 offen offset:208
  s_add_u32 s26, s23, 0xa00000
  buffer_load_dwordx4 v[40:43], v4, s[16:19], s26 offen offset:0
  buffer_load_dwordx4 v[44:47], v4, s[16:19], s26 offen offset:1024
  buffer_load_dwordx4 v[48:51], v4, s[16:19], s26 offen offset:2048
  buffer_load_dwordx4 v[52:55], v4, s[16:19], s26 offen offset:3072
  s_add_u32 s26, s26, 4096
  buffer_load_dwordx4 v[56:59], v4, s[16:19], s26 offen offset:0
  buffer_load_dwordx4 v[60:63], v4, s[16:19], s26 offen offset:1024
  buffer_load_dwordx4 v[64:67], v4, s[16:19], s26 offen offset:2048
  buffer_load_dwordx4 v[68:71], v4, s[16:19], s26 offen offset:3072
  v_add_u32 v6, 0x10000, v4
  s_waitcnt vmcnt(16)
  s_barrier
  s_cmp_lt_u32 s22, 513
  s_cbranch_scc0 B_done
  ds_read_b128 a[0:3], v4 offset:0
  ds_read_b128 a[4:7], v4 offset:1024
  ds_read_b128 a[8:11], v4 offset:2048
  ds_read_b128 a[12:15], v4 offset:3072
  ds_read_b128 a[16:19], v4 offset:4096
  ds_read_b128 a[20:23], v4 offset:5120
  ds_read_b128 a[24:27], v4 offset:6144
  ds_read_b128 a[28:31], v4 offset:7168
  ds_read_b128 a[32:35], v4 offset:8192
  ds_read_b128 a[36:39], v4 offset:9216
  ds_read_b128 a[40:43], v4 offset:10240
  ds_read_b128 a[44:47], v4 offset:11264
  ds_read_b128 a[48:51], v4 offset:12288
  ds_read_b128 a[52:55], v4 offset:13312
  ds_read_b128 a[56:59], v4 offset:14336
  ds_read_b128 a[60:63], v4 offset:15360
  ds_read_b128 a[64:67], v4 offset:16384
  ds_read_b128 a[68:71], v4 offset:17408
  ds_read_b128 a[72:75], v4 offset:18432
  ds_read_b128 a[76:79], v4 offset:19456
  ds_read_b128 a[80:83], v4 offset:20480
  ds_read_b128 a[84:87], v4 offset:21504
  ds_read_b128 a[88:91], v4 offset:22528
  ds_read_b128 a[92:95], v4 offset:23552
  ds_read_b128 a[96:99], v4 offset:49152
  ds_read_b128 a[100:103], v4 offset:50176
  ds_read_b128 a[104:107], v4 offset:51200
  ds_read_b128 a[108:111], v4 offset:52224
  ds_read_b128 a[112:115], v4 offset:53248
  ds_read_b128 a[116:119], v4 offset:54272
  s_waitcnt vmcnt(8) lgkmcnt(6)
  v_mfma_f32_32x32x16_bf16 v[144:159], v[8:11], a[0:3], 0
  v_mfma_f32_32x32x16_bf16 v[144:159], v[24:27], a[32:35], v[144:159]
  v_mfma_f32_32x32x16_bf16 v[144:159], v[12:15], a[4:7], v[144:159]
  v_mfma_f32_32x32x16_bf16 v[144:159], v[28:31], a[36:39], v[144:159]
  v_mfma_f32_32x32x16_bf16 v[144:159], v[16:19], a[8:11], v[144:159]
  v_mfma_f32_32x32x16_bf16 v[144:159], v[32:35], a[40:43], v[144:159]
  v_mfma_f32_32x32x16_bf16 v[144:159], v[20:23], a[12:15], v[144:159]
  v_mfma_f32_32x32x16_bf16 v[144:159], v[36:39], a[44:47], v[144:159]
  v_mfma_f32_32x32x16_bf16 v[176:191], v[24:27], a[0:3], 0
  v_mfma_f32_32x32x16_bf16 v[176:191], v[8:11], a[64:67], v[176:191]
  v_mfma_f32_32x32x16_bf16 v[176:191], v[28:31], a[4:7], v[176:191]
  v_mfma_f32_32x32x16_bf16 v[176:191], v[12:15], a[68:71], v[176:191]
  v_mfma_f32_32x32x16_bf16 v[176:191], v[32:35], a[8:11], v[176:191]
  v_mfma_f32_32x32x16_bf16 v[176:191], v[16:19], a[72:75], v[176:191]
  v_mfma_f32_32x32x16_bf16 v[176:191], v[36:39], a[12:15], v[176:191]
  v_mfma_f32_32x32x16_bf16 v[176:191], v[20:23], a[76:79], v[176:191]
  ds_read_b128 v[72:75], v4 offset:57344
  ds_read_b128 v[76:79], v4 offset:58368
  ds_read_b128 v[80:83], v4 offset:59392
  ds_read_b128 v[84:87], v4 offset:60416
  ds_read_b128 v[88:91], v4 offset:61440
  ds_read_b128 v[92:95], v4 offset:62464
  ds_read_b128 v[96:99], v4 offset:63488
  ds_read_b128 v[100:103], v4 offset:64512
  ds_read_b128 v[104:107], v6 offset:0
  ds_read_b128 v[108:111], v6 offset:1024
  ds_read_b128 v[112:115], v6 offset:2048
  ds_read_b128 v[116:119], v6 offset:3072
  ds_read_b128 v[120:123], v6 offset:4096
  ds_read_b128 v[124:127], v6 offset:5120
  ds_read_b128 v[128:131], v6 offset:6144
  ds_read_b128 v[132:135], v6 offset:7168
  v_mfma_f32_32x32x16_bf16 v[160:175], v[8:11], a[16:19], 0
  v_mfma_f32_32x32x16_bf16 v[160:175], v[24:27], a[48:51], v[160:175]
  v_mfma_f32_32x32x16_bf16 v[160:175], v[12:15], a[20:23], v[160:175]
  v_mfma_f32_32x32x16_bf16 v[160:175], v[28:31], a[52:55], v[160:175]
  v_mfma_f32_32x32x16_bf16 v[160:175], v[16:19], a[24:27], v[160:175]
  v_mfma_f32_32x32x16_bf16 v[160:175], v[32:35], a[56:59], v[160:175]
  v_mfma_f32_32x32x16_bf16 v[160:175], v[20:23], a[28:31], v[160:175]
  v_mfma_f32_32x32x16_bf16 v[160:175], v[36:39], a[60:63], v[160:175]
  v_mfma_f32_32x32x16_bf16 v[192:207], v[24:27], a[16:19], 0
  v_mfma_f32_32x32x16_bf16 v[192:207], v[8:11], a[80:83], v[192:207]
  v_mfma_f32_32x32x16_bf16 v[192:207], v[28:31], a[20:23], v[192:207]
  v_mfma_f32_32x32x16_bf16 v[192:207], v[12:15], a[84:87], v[192:207]
  v_mfma_f32_32x32x16_bf16 v[192:207], v[32:35], a[24:27], v[192:207]
  v_mfma_f32_32x32x16_bf16 v[192:207], v[16:19], a[88:91], v[192:207]
  v_mfma_f32_32x32x16_bf16 v[192:207], v[36:39], a[28:31], v[192:207]
  v_mfma_f32_32x32x16_bf16 v[192:207], v[20:23], a[92:95], v[192:207]
  ds_read_b128 a[120:123], v4 offset:24576
  ds_read_b128 a[124:127], v4 offset:25600
  ds_read_b128 a[128:131], v4 offset:26624
  ds_read_b128 a[132:135], v4 offset:27648
  ds_read_b128 a[136:139], v4 offset:28672
  ds_read_b128 a[140:143], v4 offset:29696
  ds_read_b128 a[144:147], v4 offset:30720
  ds_read_b128 a[148:151], v4 offset:31744
  ds_read_b128 a[152:155], v4 offset:32768
  ds_read_b128 a[156:159], v4 offset:33792
  ds_read_b128 a[160:163], v4 offset:34816
  ds_read_b128 a[164:167], v4 offset:35840
  s_waitcnt lgkmcnt(12)
  v_pk_mul_f32 v[208:209], v[144:145], v[72:73]
  v_pk_mul_f32 v[210:211], v[176:177], v[72:73]
  v_pk_fma_f32 v[208:209], v[176:177], v[74:75], v[208:209]
  v_pk_fma_f32 v[210:211], v[144:145], v[74:75], v[210:211] neg_lo:[1,0,0] neg_hi:[1,0,0]
  v_cvt_pk_bf16_f32 v8, v208, v209
  v_cvt_pk_bf16_f32 v24, v210, v211
  v_pk_mul_f32 v[208:209], v[146:147], v[76:77]
  v_pk_mul_f32 v[210:211], v[178:179], v[76:77]
  v_pk_fma_f32 v[208:209], v[178:179], v[78:79], v[208:209]
  v_pk_fma_f32 v[210:211], v[146:147], v[78:79], v[210:211] neg_lo:[1,0,0] neg_hi:[1,0,0]
  v_cvt_pk_bf16_f32 v9, v208, v209
  v_cvt_pk_bf16_f32 v25, v210, v211
  v_pk_mul_f32 v[208:209], v[148:149], v[80:81]
  v_pk_mul_f32 v[210:211], v[180:181], v[80:81]
  v_pk_fma_f32 v[208:209], v[180:181], v[82:83], v[208:209]
  v_pk_fma_f32 v[210:211], v[148:149], v[82:83], v[210:211] neg_lo:[1,0,0] neg_hi:[1,0,0]
  v_cvt_pk_bf16_f32 v10, v208, v209
  v_cvt_pk_bf16_f32 v26, v210, v211
  v_pk_mul_f32 v[208:209], v[150:151], v[84:85]
  v_pk_mul_f32 v[210:211], v[182:183], v[84:85]
  v_pk_fma_f32 v[208:209], v[182:183], v[86:87], v[208:209]
  v_pk_fma_f32 v[210:211], v[150:151], v[86:87], v[210:211] neg_lo:[1,0,0] neg_hi:[1,0,0]
  v_cvt_pk_bf16_f32 v11, v208, v209
  v_cvt_pk_bf16_f32 v27, v210, v211
  v_pk_mul_f32 v[208:209], v[152:153], v[88:89]
  v_pk_mul_f32 v[210:211], v[184:185], v[88:89]
  v_pk_fma_f32 v[208:209], v[184:185], v[90:91], v[208:209]
  v_pk_fma_f32 v[210:211], v[152:153], v[90:91], v[210:211] neg_lo:[1,0,0] neg_hi:[1,0,0]
  v_cvt_pk_bf16_f32 v12, v208, v209
  v_cvt_pk_bf16_f32 v28, v210, v211
  v_pk_mul_f32 v[208:209], v[154:155], v[92:93]
  v_pk_mul_f32 v[210:211], v[186:187], v[92:93]
  v_pk_fma_f32 v[208:209], v[186:187], v[94:95], v[208:209]
  v_pk_fma_f32 v[210:211], v[154:155], v[94:95], v[210:211] neg_lo:[1,0,0] neg_hi:[1,0,0]
  v_cvt_pk_bf16_f32 v13, v208, v209
  v_cvt_pk_bf16_f32 v29, v210, v211
  v_pk_mul_f32 v[208:209], v[156:157], v[96:97]
  v_pk_mul_f32 v[210:211], v[188:189], v[96:97]
  v_pk_fma_f32 v[208:209], v[188:189], v[98:99], v[208:209]
  v_pk_fma_f32 v[210:211], v[156:157], v[98:99], v[210:211] neg_lo:[1,0,0] neg_hi:[1,0,0]
  v_cvt_pk_bf16_f32 v14, v208, v209
  v_cvt_pk_bf16_f32 v30, v210, v211
  v_pk_mul_f32 v[208:209], v[158:159], v[100:101]
  v_pk_mul_f32 v[210:211], v[190:191], v[100:101]
  v_pk_fma_f32 v[208:209], v[190:191], v[102:103], v[208:209]
  v_pk_fma_f32 v[210:211], v[158:159], v[102:103], v[210:211] neg_lo:[1,0,0] neg_hi:[1,0,0]
  v_cvt_pk_bf16_f32 v15, v208, v209
  v_cvt_pk_bf16_f32 v31, v210, v211
  v_pk_mul_f32 v[208:209], v[160:161], v[104:105]
  v_pk_mul_f32 v[210:211], v[192:193], v[104:105]
  v_pk_fma_f32 v[208:209], v[192:193], v[106:107], v[208:209]
  v_pk_fma_f32 v[210:211], v[160:161], v[106:107], v[210:211] neg_lo:[1,0,0] neg_hi:[1,0,0]
  v_cvt_pk_bf16_f32 v16, v208, v209
  v_cvt_pk_bf16_f32 v32, v210, v211
  v_pk_mul_f32 v[208:209], v[162:163], v[108:109]
  v_pk_mul_f32 v[210:211], v[194:195], v[108:109]
  v_pk_fma_f32 v[208:209], v[194:195], v[110:111], v[208:209]
  v_pk_fma_f32 v[210:211], v[162:163], v[110:111], v[210:211] neg_lo:[1,0,0] neg_hi:[1,0,0]
  v_cvt_pk_bf16_f32 v17, v208, v209
  v_cvt_pk_bf16_f32 v33, v210, v211
  v_pk_mul_f32 v[208:209], v[164:165], v[112:113]
  v_pk_mul_f32 v[210:211], v[196:197], v[112:113]
  v_pk_fma_f32 v[208:209], v[196:197], v[114:115], v[208:209]
  v_pk_fma_f32 v[210:211], v[164:165], v[114:115], v[210:211] neg_lo:[1,0,0] neg_hi:[1,0,0]
  v_cvt_pk_bf16_f32 v18, v208, v209
  v_cvt_pk_bf16_f32 v34, v210, v211
  v_pk_mul_f32 v[208:209], v[166:167], v[116:117]
  v_pk_mul_f32 v[210:211], v[198:199], v[116:117]
  v_pk_fma_f32 v[208:209], v[198:199], v[118:119], v[208:209]
  v_pk_fma_f32 v[210:211], v[166:167], v[118:119], v[210:211] neg_lo:[1,0,0] neg_hi:[1,0,0]
  v_cvt_pk_bf16_f32 v19, v208, v209
  v_cvt_pk_bf16_f32 v35, v210, v211
  v_pk_mul_f32 v[208:209], v[168:169], v[120:121]
  v_pk_mul_f32 v[210:211], v[200:201], v[120:121]
  v_pk_fma_f32 v[208:209], v[200:201], v[122:123], v[208:209]
  v_pk_fma_f32 v[210:211], v[168:169], v[122:123], v[210:211] neg_lo:[1,0,0] neg_hi:[1,0,0]
  v_cvt_pk_bf16_f32 v20, v208, v209
  v_cvt_pk_bf16_f32 v36, v210, v211
  v_pk_mul_f32 v[208:209], v[170:171], v[124:125]
  v_pk_mul_f32 v[210:211], v[202:203], v[124:125]
  v_pk_fma_f32 v[208:209], v[202:203], v[126:127], v[208:209]
  v_pk_fma_f32 v[210:211], v[170:171], v[126:127], v[210:211] neg_lo:[1,0,0] neg_hi:[1,0,0]
  v_cvt_pk_bf16_f32 v21, v208, v209
  v_cvt_pk_bf16_f32 v37, v210, v211
  v_pk_mul_f32 v[208:209], v[172:173], v[128:129]
  v_pk_mul_f32 v[210:211], v[204:205], v[128:129]
  v_pk_fma_f32 v[208:209], v[204:205], v[130:131], v[208:209]
  v_pk_fma_f32 v[210:211], v[172:173], v[130:131], v[210:211] neg_lo:[1,0,0] neg_hi:[1,0,0]
  v_cvt_pk_bf16_f32 v22, v208, v209
  v_cvt_pk_bf16_f32 v38, v210, v211
  v_pk_mul_f32 v[208:209], v[174:175], v[132:133]
  v_pk_mul_f32 v[210:211], v[206:207], v[132:133]
  v_pk_fma_f32 v[208:209], v[206:207], v[134:135], v[208:209]
  v_pk_fma_f32 v[210:211], v[174:175], v[134:135], v[210:211] neg_lo:[1,0,0] neg_hi:[1,0,0]
  v_cvt_pk_bf16_f32 v23, v208, v209
  v_cvt_pk_bf16_f32 v39, v210, v211
  v_mfma_f32_32x32x16_bf16 v[144:159], a[96:99], v[8:11], 0
  v_mfma_f32_32x32x16_bf16 v[144:159], a[104:107], v[24:27], v[144:159]
  v_mfma_f32_32x32x16_bf16 v[144:159], a[100:103], v[12:15], v[144:159]
  v_mfma_f32_32x32x16_bf16 v[144:159], a[108:111], v[28:31], v[144:159]
  v_mfma_f32_32x32x16_bf16 v[176:191], a[96:99], v[24:27], 0
  v_mfma_f32_32x32x16_bf16 v[176:191], a[112:115], v[8:11], v[176:191]
  v_mfma_f32_32x32x16_bf16 v[176:191], a[100:103], v[28:31], v[176:191]
  v_mfma_f32_32x32x16_bf16 v[176:191], a[116:119], v[12:15], v[176:191]
  v_mfma_f32_32x32x16_bf16 v[160:175], a[96:99], v[16:19], 0
  v_mfma_f32_32x32x16_bf16 v[160:175], a[104:107], v[32:35], v[160:175]
  v_mfma_f32_32x32x16_bf16 v[160:175], a[100:103], v[20:23], v[160:175]
  v_mfma_f32_32x32x16_bf16 v[160:175], a[108:111], v[36:39], v[160:175]
  v_mfma_f32_32x32x16_bf16 v[192:207], a[96:99], v[32:35], 0
  v_mfma_f32_32x32x16_bf16 v[192:207], a[112:115], v[16:19], v[192:207]
  v_mfma_f32_32x32x16_bf16 v[192:207], a[100:103], v[36:39], v[192:207]
  v_mfma_f32_32x32x16_bf16 v[192:207], a[116:119], v[20:23], v[192:207]
  s_waitcnt lgkmcnt(0)
  ds_read_b128 a[168:171], v4 offset:36864
  ds_read_b128 a[172:175], v4 offset:37888
  ds_read_b128 a[176:179], v4 offset:38912
  ds_read_b128 a[180:183], v4 offset:39936
  ds_read_b128 a[184:187], v4 offset:40960
  ds_read_b128 a[188:191], v4 offset:41984
  ds_read_b128 a[192:195], v4 offset:43008
  ds_read_b128 a[196:199], v4 offset:44032
  ds_read_b128 a[200:203], v4 offset:45056
  ds_read_b128 a[204:207], v4 offset:46080
  ds_read_b128 a[208:211], v4 offset:47104
  ds_read_b128 a[212:215], v4 offset:48128
  ds_read_b128 v[72:75], v6 offset:8192
  ds_read_b128 v[76:79], v6 offset:9216
  ds_read_b128 v[80:83], v6 offset:10240
  ds_read_b128 v[84:87], v6 offset:11264
  ds_read_b128 v[88:91], v6 offset:12288
  ds_read_b128 v[92:95], v6 offset:13312
  ds_read_b128 v[96:99], v6 offset:14336
  ds_read_b128 v[100:103], v6 offset:15360
  ds_read_b128 v[104:107], v6 offset:16384
  ds_read_b128 v[108:111], v6 offset:17408
  ds_read_b128 v[112:115], v6 offset:18432
  ds_read_b128 v[116:119], v6 offset:19456
  ds_read_b128 v[120:123], v6 offset:20480
  ds_read_b128 v[124:127], v6 offset:21504
  ds_read_b128 v[128:131], v6 offset:22528
  ds_read_b128 v[132:135], v6 offset:23552
  s_waitcnt vmcnt(0)
  v_lshlrev_b32 v212, 16, v40
  v_lshlrev_b32 v213, 16, v41
  v_and_b32 v214, 0xffff0000, v40
  v_and_b32 v215, 0xffff0000, v41
  v_pk_mul_f32 v[208:209], v[144:145], v[212:213]
  v_pk_mul_f32 v[210:211], v[176:177], v[212:213]
  v_pk_fma_f32 v[208:209], v[176:177], v[214:215], v[208:209] neg_lo:[1,0,0] neg_hi:[1,0,0]
  v_pk_fma_f32 v[210:211], v[144:145], v[214:215], v[210:211]
  v_cvt_pk_bf16_f32 v8, v208, v209
  v_cvt_pk_bf16_f32 v24, v210, v211
  v_lshlrev_b32 v212, 16, v42
  v_lshlrev_b32 v213, 16, v43
  v_and_b32 v214, 0xffff0000, v42
  v_and_b32 v215, 0xffff0000, v43
  v_pk_mul_f32 v[208:209], v[146:147], v[212:213]
  v_pk_mul_f32 v[210:211], v[178:179], v[212:213]
  v_pk_fma_f32 v[208:209], v[178:179], v[214:215], v[208:209] neg_lo:[1,0,0] neg_hi:[1,0,0]
  v_pk_fma_f32 v[210:211], v[146:147], v[214:215], v[210:211]
  v_cvt_pk_bf16_f32 v9, v208, v209
  v_cvt_pk_bf16_f32 v25, v210, v211
  v_lshlrev_b32 v212, 16, v44
  v_lshlrev_b32 v213, 16, v45
  v_and_b32 v214, 0xffff0000, v44
  v_and_b32 v215, 0xffff0000, v45
  v_pk_mul_f32 v[208:209], v[148:149], v[212:213]
  v_pk_mul_f32 v[210:211], v[180:181], v[212:213]
  v_pk_fma_f32 v[208:209], v[180:181], v[214:215], v[208:209] neg_lo:[1,0,0] neg_hi:[1,0,0]
  v_pk_fma_f32 v[210:211], v[148:149], v[214:215], v[210:211]
  v_cvt_pk_bf16_f32 v10, v208, v209
  v_cvt_pk_bf16_f32 v26, v210, v211
  v_lshlrev_b32 v212, 16, v46
  v_lshlrev_b32 v213, 16, v47
  v_and_b32 v214, 0xffff0000, v46
  v_and_b32 v215, 0xffff0000, v47
  v_pk_mul_f32 v[208:209], v[150:151], v[212:213]
  v_pk_mul_f32 v[210:211], v[182:183], v[212:213]
  v_pk_fma_f32 v[208:209], v[182:183], v[214:215], v[208:209] neg_lo:[1,0,0] neg_hi:[1,0,0]
  v_pk_fma_f32 v[210:211], v[150:151], v[214:215], v[210:211]
  v_cvt_pk_bf16_f32 v11, v208, v209
  v_cvt_pk_bf16_f32 v27, v210, v211
  v_lshlrev_b32 v212, 16, v48
  v_lshlrev_b32 v213, 16, v49
  v_and_b32 v214, 0xffff0000, v48
  v_and_b32 v215, 0xffff0000, v49
  v_pk_mul_f32 v[208:209], v[152:153], v[212:213]
  v_pk_mul_f32 v[210:211], v[184:185], v[212:213]
  v_pk_fma_f32 v[208:209], v[184:185], v[214:215], v[208:209] neg_lo:[1,0,0] neg_hi:[1,0,0]
  v_pk_fma_f32 v[210:211], v[152:153], v[214:215], v[210:211]
  v_cvt_pk_bf16_f32 v12, v208, v209
  v_cvt_pk_bf16_f32 v28, v210, v211
  v_lshlrev_b32 v212, 16, v50
  v_lshlrev_b32 v213, 16, v51
  v_and_b32 v214, 0xffff0000, v50
  v_and_b32 v215, 0xffff0000, v51
  v_pk_mul_f32 v[208:209], v[154:155], v[212:213]
  v_pk_mul_f32 v[210:211], v[186:187], v[212:213]
  v_pk_fma_f32 v[208:209], v[186:187], v[214:215], v[208:209] neg_lo:[1,0,0] neg_hi:[1,0,0]
  v_pk_fma_f32 v[210:211], v[154:155], v[214:215], v[210:211]
  v_cvt_pk_bf16_f32 v13, v208, v209
  v_cvt_pk_bf16_f32 v29, v210, v211
  v_lshlrev_b32 v212, 16, v52
  v_lshlrev_b32 v213, 16, v53
  v_and_b32 v214, 0xffff0000, v52
  v_and_b32 v215, 0xffff0000, v53
  v_pk_mul_f32 v[208:209], v[156:157], v[212:213]
  v_pk_mul_f32 v[210:211], v[188:189], v[212:213]
  v_pk_fma_f32 v[208:209], v[188:189], v[214:215], v[208:209] neg_lo:[1,0,0] neg_hi:[1,0,0]
  v_pk_fma_f32 v[210:211], v[156:157], v[214:215], v[210:211]
  v_cvt_pk_bf16_f32 v14, v208, v209
  v_cvt_pk_bf16_f32 v30, v210, v211
  v_lshlrev_b32 v212, 16, v54
  v_lshlrev_b32 v213, 16, v55
  v_and_b32 v214, 0xffff0000, v54
  v_and_b32 v215, 0xffff0000, v55
  v_pk_mul_f32 v[208:209], v[158:159], v[212:213]
  v_pk_mul_f32 v[210:211], v[190:191], v[212:213]
  v_pk_fma_f32 v[208:209], v[190:191], v[214:215], v[208:209] neg_lo:[1,0,0] neg_hi:[1,0,0]
  v_pk_fma_f32 v[210:211], v[158:159], v[214:215], v[210:211]
  v_cvt_pk_bf16_f32 v15, v208, v209
  v_cvt_pk_bf16_f32 v31, v210, v211
  v_lshlrev_b32 v212, 16, v56
  v_lshlrev_b32 v213, 16, v57
  v_and_b32 v214, 0xffff0000, v56
  v_and_b32 v215, 0xffff0000, v57
  v_pk_mul_f32 v[208:209], v[160:161], v[212:213]
  v_pk_mul_f32 v[210:211], v[192:193], v[212:213]
  v_pk_fma_f32 v[208:209], v[192:193], v[214:215], v[208:209] neg_lo:[1,0,0] neg_hi:[1,0,0]
  v_pk_fma_f32 v[210:211], v[160:161], v[214:215], v[210:211]
  v_cvt_pk_bf16_f32 v16, v208, v209
  v_cvt_pk_bf16_f32 v32, v210, v211
  v_lshlrev_b32 v212, 16, v58
  v_lshlrev_b32 v213, 16, v59
  v_and_b32 v214, 0xffff0000, v58
  v_and_b32 v215, 0xffff0000, v59
  v_pk_mul_f32 v[208:209], v[162:163], v[212:213]
  v_pk_mul_f32 v[210:211], v[194:195], v[212:213]
  v_pk_fma_f32 v[208:209], v[194:195], v[214:215], v[208:209] neg_lo:[1,0,0] neg_hi:[1,0,0]
  v_pk_fma_f32 v[210:211], v[162:163], v[214:215], v[210:211]
  v_cvt_pk_bf16_f32 v17, v208, v209
  v_cvt_pk_bf16_f32 v33, v210, v211
  v_lshlrev_b32 v212, 16, v60
  v_lshlrev_b32 v213, 16, v61
  v_and_b32 v214, 0xffff0000, v60
  v_and_b32 v215, 0xffff0000, v61
  v_pk_mul_f32 v[208:209], v[164:165], v[212:213]
  v_pk_mul_f32 v[210:211], v[196:197], v[212:213]
  v_pk_fma_f32 v[208:209], v[196:197], v[214:215], v[208:209] neg_lo:[1,0,0] neg_hi:[1,0,0]
  v_pk_fma_f32 v[210:211], v[164:165], v[214:215], v[210:211]
  v_cvt_pk_bf16_f32 v18, v208, v209
  v_cvt_pk_bf16_f32 v34, v210, v211
  v_lshlrev_b32 v212, 16, v62
  v_lshlrev_b32 v213, 16, v63
  v_and_b32 v214, 0xffff0000, v62
  v_and_b32 v215, 0xffff0000, v63
  v_pk_mul_f32 v[208:209], v[166:167], v[212:213]
  v_pk_mul_f32 v[210:211], v[198:199], v[212:213]
  v_pk_fma_f32 v[208:209], v[198:199], v[214:215], v[208:209] neg_lo:[1,0,0] neg_hi:[1,0,0]
  v_pk_fma_f32 v[210:211], v[166:167], v[214:215], v[210:211]
  v_cvt_pk_bf16_f32 v19, v208, v209
  v_cvt_pk_bf16_f32 v35, v210, v211
  v_lshlrev_b32 v212, 16, v64
  v_lshlrev_b32 v213, 16, v65
  v_and_b32 v214, 0xffff0000, v64
  v_and_b32 v215, 0xffff0000, v65
  v_pk_mul_f32 v[208:209], v[168:169], v[212:213]
  v_pk_mul_f32 v[210:211], v[200:201], v[212:213]
  v_pk_fma_f32 v[208:209], v[200:201], v[214:215], v[208:209] neg_lo:[1,0,0] neg_hi:[1,0,0]
  v_pk_fma_f32 v[210:211], v[168:169], v[214:215], v[210:211]
  v_cvt_pk_bf16_f32 v20, v208, v209
  v_cvt_pk_bf16_f32 v36, v210, v211
  v_lshlrev_b32 v212, 16, v66
  v_lshlrev_b32 v213, 16, v67
  v_and_b32 v214, 0xffff0000, v66
  v_and_b32 v215, 0xffff0000, v67
  v_pk_mul_f32 v[208:209], v[170:171], v[212:213]
  v_pk_mul_f32 v[210:211], v[202:203], v[212:213]
  v_pk_fma_f32 v[208:209], v[202:203], v[214:215], v[208:209] neg_lo:[1,0,0] neg_hi:[1,0,0]
  v_pk_fma_f32 v[210:211], v[170:171], v[214:215], v[210:211]
  v_cvt_pk_bf16_f32 v21, v208, v209
  v_cvt_pk_bf16_f32 v37, v210, v211
  v_lshlrev_b32 v212, 16, v68
  v_lshlrev_b32 v213, 16, v69
  v_and_b32 v214, 0xffff0000, v68
  v_and_b32 v215, 0xffff0000, v69
  v_pk_mul_f32 v[208:209], v[172:173], v[212:213]
  v_pk_mul_f32 v[210:211], v[204:205], v[212:213]
  v_pk_fma_f32 v[208:209], v[204:205], v[214:215], v[208:209] neg_lo:[1,0,0] neg_hi:[1,0,0]
  v_pk_fma_f32 v[210:211], v[172:173], v[214:215], v[210:211]
  v_cvt_pk_bf16_f32 v22, v208, v209
  v_cvt_pk_bf16_f32 v38, v210, v211
  v_lshlrev_b32 v212, 16, v70
  v_lshlrev_b32 v213, 16, v71
  v_and_b32 v214, 0xffff0000, v70
  v_and_b32 v215, 0xffff0000, v71
  v_pk_mul_f32 v[208:209], v[174:175], v[212:213]
  v_pk_mul_f32 v[210:211], v[206:207], v[212:213]
  v_pk_fma_f32 v[208:209], v[206:207], v[214:215], v[208:209] neg_lo:[1,0,0] neg_hi:[1,0,0]
  v_pk_fma_f32 v[210:211], v[174:175], v[214:215], v[210:211]
  v_cvt_pk_bf16_f32 v23, v208, v209
  v_cvt_pk_bf16_f32 v39, v210, v211
  v_mfma_f32_32x32x16_bf16 v[144:159], v[8:11], a[96:99], 0
  v_mfma_f32_32x32x16_bf16 v[144:159], v[24:27], a[112:115], v[144:159]
  v_mfma_f32_32x32x16_bf16 v[144:159], v[12:15], a[100:103], v[144:159]
  v_mfma_f32_32x32x16_bf16 v[144:159], v[28:31], a[116:119], v[144:159]
  v_mfma_f32_32x32x16_bf16 v[176:191], v[24:27], a[96:99], 0
  v_mfma_f32_32x32x16_bf16 v[176:191], v[8:11], a[104:107], v[176:191]
  v_mfma_f32_32x32x16_bf16 v[176:191], v[28:31], a[100:103], v[176:191]
  v_mfma_f32_32x32x16_bf16 v[176:191], v[12:15], a[108:111], v[176:191]
  v_mfma_f32_32x32x16_bf16 v[160:175], v[16:19], a[96:99], 0
  v_mfma_f32_32x32x16_bf16 v[160:175], v[32:35], a[112:115], v[160:175]
  v_mfma_f32_32x32x16_bf16 v[160:175], v[20:23], a[100:103], v[160:175]
  v_mfma_f32_32x32x16_bf16 v[160:175], v[36:39], a[116:119], v[160:175]
  v_mfma_f32_32x32x16_bf16 v[192:207], v[32:35], a[96:99], 0
  v_mfma_f32_32x32x16_bf16 v[192:207], v[16:19], a[104:107], v[192:207]
  v_mfma_f32_32x32x16_bf16 v[192:207], v[36:39], a[100:103], v[192:207]
  v_mfma_f32_32x32x16_bf16 v[192:207], v[20:23], a[108:111], v[192:207]
  s_waitcnt lgkmcnt(0)
  v_pk_mul_f32 v[208:209], v[144:145], v[72:73]
  s_nop 1
  v_pk_mul_f32 v[210:211], v[176:177], v[72:73]
  v_pk_fma_f32 v[208:209], v[176:177], v[74:75], v[208:209] neg_lo:[1,0,0] neg_hi:[1,0,0]
  v_pk_fma_f32 v[210:211], v[144:145], v[74:75], v[210:211]
  v_cvt_pk_bf16_f32 v8, v208, v209
  v_cvt_pk_bf16_f32 v24, v210, v211
  v_pk_mul_f32 v[208:209], v[146:147], v[76:77]
  v_pk_mul_f32 v[210:211], v[178:179], v[76:77]
  v_pk_fma_f32 v[208:209], v[178:179], v[78:79], v[208:209] neg_lo:[1,0,0] neg_hi:[1,0,0]
  v_pk_fma_f32 v[210:211], v[146:147], v[78:79], v[210:211]
  v_cvt_pk_bf16_f32 v9, v208, v209
  v_cvt_pk_bf16_f32 v25, v210, v211
  v_pk_mul_f32 v[208:209], v[148:149], v[80:81]
  v_pk_mul_f32 v[210:211], v[180:181], v[80:81]
  v_pk_fma_f32 v[208:209], v[180:181], v[82:83], v[208:209] neg_lo:[1,0,0] neg_hi:[1,0,0]
  v_pk_fma_f32 v[210:211], v[148:149], v[82:83], v[210:211]
  v_cvt_pk_bf16_f32 v10, v208, v209
  v_cvt_pk_bf16_f32 v26, v210, v211
  v_pk_mul_f32 v[208:209], v[150:151], v[84:85]
  v_pk_mul_f32 v[210:211], v[182:183], v[84:85]
  v_pk_fma_f32 v[208:209], v[182:183], v[86:87], v[208:209] neg_lo:[1,0,0] neg_hi:[1,0,0]
  v_pk_fma_f32 v[210:211], v[150:151], v[86:87], v[210:211]
  v_cvt_pk_bf16_f32 v11, v208, v209
  v_cvt_pk_bf16_f32 v27, v210, v211
  v_pk_mul_f32 v[208:209], v[152:153], v[88:89]
  v_pk_mul_f32 v[210:211], v[184:185], v[88:89]
  v_pk_fma_f32 v[208:209], v[184:185], v[90:91], v[208:209] neg_lo:[1,0,0] neg_hi:[1,0,0]
  v_pk_fma_f32 v[210:211], v[152:153], v[90:91], v[210:211]
  v_cvt_pk_bf16_f32 v12, v208, v209
  v_cvt_pk_bf16_f32 v28, v210, v211
  v_pk_mul_f32 v[208:209], v[154:155], v[92:93]
  v_pk_mul_f32 v[210:211], v[186:187], v[92:93]
  v_pk_fma_f32 v[208:209], v[186:187], v[94:95], v[208:209] neg_lo:[1,0,0] neg_hi:[1,0,0]
  v_pk_fma_f32 v[210:211], v[154:155], v[94:95], v[210:211]
  v_cvt_pk_bf16_f32 v13, v208, v209
  v_cvt_pk_bf16_f32 v29, v210, v211
  v_pk_mul_f32 v[208:209], v[156:157], v[96:97]
  v_pk_mul_f32 v[210:211], v[188:189], v[96:97]
  v_pk_fma_f32 v[208:209], v[188:189], v[98:99], v[208:209] neg_lo:[1,0,0] neg_hi:[1,0,0]
  v_pk_fma_f32 v[210:211], v[156:157], v[98:99], v[210:211]
  v_cvt_pk_bf16_f32 v14, v208, v209
  v_cvt_pk_bf16_f32 v30, v210, v211
  v_pk_mul_f32 v[208:209], v[158:159], v[100:101]
  v_pk_mul_f32 v[210:211], v[190:191], v[100:101]
  v_pk_fma_f32 v[208:209], v[190:191], v[102:103], v[208:209] neg_lo:[1,0,0] neg_hi:[1,0,0]
  v_pk_fma_f32 v[210:211], v[158:159], v[102:103], v[210:211]
  v_cvt_pk_bf16_f32 v15, v208, v209
  v_cvt_pk_bf16_f32 v31, v210, v211
  v_pk_mul_f32 v[208:209], v[160:161], v[104:105]
  v_pk_mul_f32 v[210:211], v[192:193], v[104:105]
  v_pk_fma_f32 v[208:209], v[192:193], v[106:107], v[208:209] neg_lo:[1,0,0] neg_hi:[1,0,0]
  v_pk_fma_f32 v[210:211], v[160:161], v[106:107], v[210:211]
  v_cvt_pk_bf16_f32 v16, v208, v209
  v_cvt_pk_bf16_f32 v32, v210, v211
  v_pk_mul_f32 v[208:209], v[162:163], v[108:109]
  v_pk_mul_f32 v[210:211], v[194:195], v[108:109]
  v_pk_fma_f32 v[208:209], v[194:195], v[110:111], v[208:209] neg_lo:[1,0,0] neg_hi:[1,0,0]
  v_pk_fma_f32 v[210:211], v[162:163], v[110:111], v[210:211]
  v_cvt_pk_bf16_f32 v17, v208, v209
  v_cvt_pk_bf16_f32 v33, v210, v211
  v_pk_mul_f32 v[208:209], v[164:165], v[112:113]
  v_pk_mul_f32 v[210:211], v[196:197], v[112:113]
  v_pk_fma_f32 v[208:209], v[196:197], v[114:115], v[208:209] neg_lo:[1,0,0] neg_hi:[1,0,0]
  v_pk_fma_f32 v[210:211], v[164:165], v[114:115], v[210:211]
  v_cvt_pk_bf16_f32 v18, v208, v209
  v_cvt_pk_bf16_f32 v34, v210, v211
  v_pk_mul_f32 v[208:209], v[166:167], v[116:117]
  v_pk_mul_f32 v[210:211], v[198:199], v[116:117]
  v_pk_fma_f32 v[208:209], v[198:199], v[118:119], v[208:209] neg_lo:[1,0,0] neg_hi:[1,0,0]
  v_pk_fma_f32 v[210:211], v[166:167], v[118:119], v[210:211]
  v_cvt_pk_bf16_f32 v19, v208, v209
  v_cvt_pk_bf16_f32 v35, v210, v211
  v_pk_mul_f32 v[208:209], v[168:169], v[120:121]
  v_pk_mul_f32 v[210:211], v[200:201], v[120:121]
  v_pk_fma_f32 v[208:209], v[200:201], v[122:123], v[208:209] neg_lo:[1,0,0] neg_hi:[1,0,0]
  v_pk_fma_f32 v[210:211], v[168:169], v[122:123], v[210:211]
  v_cvt_pk_bf16_f32 v20, v208, v209
  v_cvt_pk_bf16_f32 v36, v210, v211
  v_pk_mul_f32 v[208:209], v[170:171], v[124:125]
  v_pk_mul_f32 v[210:211], v[202:203], v[124:125]
  v_pk_fma_f32 v[208:209], v[202:203], v[126:127], v[208:209] neg_lo:[1,0,0] neg_hi:[1,0,0]
  v_pk_fma_f32 v[210:211], v[170:171], v[126:127], v[210:211]
  v_cvt_pk_bf16_f32 v21, v208, v209
  v_cvt_pk_bf16_f32 v37, v210, v211
  v_pk_mul_f32 v[208:209], v[172:173], v[128:129]
  v_pk_mul_f32 v[210:211], v[204:205], v[128:129]
  v_pk_fma_f32 v[208:209], v[204:205], v[130:131], v[208:209] neg_lo:[1,0,0] neg_hi:[1,0,0]
  v_pk_fma_f32 v[210:211], v[172:173], v[130:131], v[210:211]
  v_cvt_pk_bf16_f32 v22, v208, v209
  v_cvt_pk_bf16_f32 v38, v210, v211
  v_pk_mul_f32 v[208:209], v[174:175], v[132:133]
  v_pk_mul_f32 v[210:211], v[206:207], v[132:133]
  v_pk_fma_f32 v[208:209], v[206:207], v[134:135], v[208:209] neg_lo:[1,0,0] neg_hi:[1,0,0]
  v_pk_fma_f32 v[210:211], v[174:175], v[134:135], v[210:211]
  v_cvt_pk_bf16_f32 v23, v208, v209
  v_cvt_pk_bf16_f32 v39, v210, v211
  v_mfma_f32_32x32x16_bf16 v[144:159], a[120:123], v[8:11], 0
  v_mfma_f32_32x32x16_bf16 v[144:159], a[184:187], v[24:27], v[144:159]
  v_mfma_f32_32x32x16_bf16 v[144:159], a[124:127], v[12:15], v[144:159]
  v_mfma_f32_32x32x16_bf16 v[144:159], a[188:191], v[28:31], v[144:159]
  v_mfma_f32_32x32x16_bf16 v[144:159], a[128:131], v[16:19], v[144:159]
  v_mfma_f32_32x32x16_bf16 v[144:159], a[192:195], v[32:35], v[144:159]
  v_mfma_f32_32x32x16_bf16 v[144:159], a[132:135], v[20:23], v[144:159]
  v_mfma_f32_32x32x16_bf16 v[144:159], a[196:199], v[36:39], v[144:159]
  v_mfma_f32_32x32x16_bf16 v[176:191], a[120:123], v[24:27], 0
  v_mfma_f32_32x32x16_bf16 v[176:191], a[152:155], v[8:11], v[176:191]
  v_mfma_f32_32x32x16_bf16 v[176:191], a[124:127], v[28:31], v[176:191]
  v_mfma_f32_32x32x16_bf16 v[176:191], a[156:159], v[12:15], v[176:191]
  v_mfma_f32_32x32x16_bf16 v[176:191], a[128:131], v[32:35], v[176:191]
  v_mfma_f32_32x32x16_bf16 v[176:191], a[160:163], v[16:19], v[176:191]
  v_mfma_f32_32x32x16_bf16 v[176:191], a[132:135], v[36:39], v[176:191]
  v_mfma_f32_32x32x16_bf16 v[176:191], a[164:167], v[20:23], v[176:191]
  v_mfma_f32_32x32x16_bf16 v[160:175], a[136:139], v[8:11], 0
  v_mfma_f32_32x32x16_bf16 v[160:175], a[200:203], v[24:27], v[160:175]
  v_mfma_f32_32x32x16_bf16 v[160:175], a[140:143], v[12:15], v[160:175]
  v_mfma_f32_32x32x16_bf16 v[160:175], a[204:207], v[28:31], v[160:175]
  v_mfma_f32_32x32x16_bf16 v[160:175], a[144:147], v[16:19], v[160:175]
  v_mfma_f32_32x32x16_bf16 v[160:175], a[208:211], v[32:35], v[160:175]
  v_mfma_f32_32x32x16_bf16 v[160:175], a[148:151], v[20:23], v[160:175]
  v_mfma_f32_32x32x16_bf16 v[160:175], a[212:215], v[36:39], v[160:175]
  v_mfma_f32_32x32x16_bf16 v[192:207], a[136:139], v[24:27], 0
  v_mfma_f32_32x32x16_bf16 v[192:207], a[168:171], v[8:11], v[192:207]
  v_mfma_f32_32x32x16_bf16 v[192:207], a[140:143], v[28:31], v[192:207]
  v_mfma_f32_32x32x16_bf16 v[192:207], a[172:175], v[12:15], v[192:207]
  v_mfma_f32_32x32x16_bf16 v[192:207], a[144:147], v[32:35], v[192:207]
  v_mfma_f32_32x32x16_bf16 v[192:207], a[176:179], v[16:19], v[192:207]
  v_mfma_f32_32x32x16_bf16 v[192:207], a[148:151], v[36:39], v[192:207]
  v_mfma_f32_32x32x16_bf16 v[192:207], a[180:183], v[20:23], v[192:207]
  s_cmp_eq_u32 s21, 4
  s_cbranch_scc1 B_nyq
  v_lshlrev_b32 v5, 4, v2
  v_lshl_add_u32 v5, v3, 11, v5
  s_lshl_b32 s24, s3, 1
  s_add_u32 s24, s24, 0x16000
  v_add_u32 v5, s24, v5
  v_cvt_pk_bf16_f32 v72, v144, v176
  ds_write_b16 v5, v72 offset:0
  ds_write_b16_d16_hi v5, v72 offset:8
  v_cvt_pk_bf16_f32 v73, v145, v177
  ds_write_b16 v5, v73 offset:512
  ds_write_b16_d16_hi v5, v73 offset:520
  v_cvt_pk_bf16_f32 v74, v146, v178
  ds_write_b16 v5, v74 offset:1024
  ds_write_b16_d16_hi v5, v74 offset:1032
  v_cvt_pk_bf16_f32 v75, v147, v179
  ds_write_b16 v5, v75 offset:1536
  ds_write_b16_d16_hi v5, v75 offset:1544
  v_cvt_pk_bf16_f32 v76, v148, v180
  ds_write_b16 v5, v76 offset:4096
  ds_write_b16_d16_hi v5, v76 offset:4104
  v_cvt_pk_bf16_f32 v77, v149, v181
  ds_write_b16 v5, v77 offset:4608
  ds_write_b16_d16_hi v5, v77 offset:4616
  v_cvt_pk_bf16_f32 v78, v150, v182
  ds_write_b16 v5, v78 offset:5120
  ds_write_b16_d16_hi v5, v78 offset:5128
  v_cvt_pk_bf16_f32 v79, v151, v183
  ds_write_b16 v5, v79 offset:5632
  ds_write_b16_d16_hi v5, v79 offset:5640
  v_cvt_pk_bf16_f32 v80, v152, v184
  ds_write_b16 v5, v80 offset:8192
  ds_write_b16_d16_hi v5, v80 offset:8200
  v_cvt_pk_bf16_f32 v81, v153, v185
  ds_write_b16 v5, v81 offset:8704
  ds_write_b16_d16_hi v5, v81 offset:8712
  v_cvt_pk_bf16_f32 v82, v154, v186
  ds_write_b16 v5, v82 offset:9216
  ds_write_b16_d16_hi v5, v82 offset:9224
  v_cvt_pk_bf16_f32 v83, v155, v187
  ds_write_b16 v5, v83 offset:9728
  ds_write_b16_d16_hi v5, v83 offset:9736
  v_cvt_pk_bf16_f32 v84, v156, v188
  ds_write_b16 v5, v84 offset:12288
  ds_write_b16_d16_hi v5, v84 offset:12296
  v_cvt_pk_bf16_f32 v85, v157, v189
  ds_write_b16 v5, v85 offset:12800
  ds_write_b16_d16_hi v5, v85 offset:12808
  v_cvt_pk_bf16_f32 v86, v158, v190
  ds_write_b16 v5, v86 offset:13312
  ds_write_b16_d16_hi v5, v86 offset:13320
  v_cvt_pk_bf16_f32 v87, v159, v191
  ds_write_b16 v5, v87 offset:13824
  ds_write_b16_d16_hi v5, v87 offset:13832
  v_cvt_pk_bf16_f32 v88, v160, v192
  ds_write_b16 v5, v88 offset:16384
  ds_write_b16_d16_hi v5, v88 offset:16392
  v_cvt_pk_bf16_f32 v89, v161, v193
  ds_write_b16 v5, v89 offset:16896
  ds_write_b16_d16_hi v5, v89 offset:16904
  v_cvt_pk_bf16_f32 v90, v162, v194
  ds_write_b16 v5, v90 offset:17408
  ds_write_b16_d16_hi v5, v90 offset:17416
  v_cvt_pk_bf16_f32 v91, v163, v195
  ds_write_b16 v5, v91 offset:17920
  ds_write_b16_d16_hi v5, v91 offset:17928
  v_cvt_pk_bf16_f32 v92, v164, v196
  ds_write_b16 v5, v92 offset:20480
  ds_write_b16_d16_hi v5, v92 offset:20488
  v_cvt_pk_bf16_f32 v93, v165, v197
  ds_write_b16 v5, v93 offset:20992
  ds_write_b16_d16_hi v5, v93 offset:21000
  v_cvt_pk_bf16_f32 v94, v166, v198
  ds_write_b16 v5, v94 offset:21504
  ds_write_b16_d16_hi v5, v94 offset:21512
  v_cvt_pk_bf16_f32 v95, v167, v199
  ds_write_b16 v5, v95 offset:22016
  ds_write_b16_d16_hi v5, v95 offset:22024
  v_cvt_pk_bf16_f32 v96, v168, v200
  ds_write_b16 v5, v96 offset:24576
  ds_write_b16_d16_hi v5, v96 offset:24584
  v_cvt_pk_bf16_f32 v97, v169, v201
  ds_write_b16 v5, v97 offset:25088
  ds_write_b16_d16_hi v5, v97 offset:25096
  v_cvt_pk_bf16_f32 v98, v170, v202
  ds_write_b16 v5, v98 offset:25600
  ds_write_b16_d16_hi v5, v98 offset:25608
  v_cvt_pk_bf16_f32 v99, v171, v203
  ds_write_b16 v5, v99 offset:26112
  ds_write_b16_d16_hi v5, v99 offset:26120
  v_cvt_pk_bf16_f32 v100, v172, v204
  ds_write_b16 v5, v100 offset:28672
  ds_write_b16_d16_hi v5, v100 offset:28680
  v_cvt_pk_bf16_f32 v101, v173, v205
  ds_write_b16 v5, v101 offset:29184
  ds_write_b16_d16_hi v5, v101 offset:29192
  v_cvt_pk_bf16_f32 v102, v174, v206
  ds_write_b16 v5, v102 offset:29696
  ds_write_b16_d16_hi v5, v102 offset:29704
  v_cvt_pk_bf16_f32 v103, v175, v207
  ds_write_b16 v5, v103 offset:30208
  ds_write_b16_d16_hi v5, v103 offset:30216
  s_waitcnt lgkmcnt(0)
  s_barrier
  v_lshlrev_b32 v5, 4, v0
  v_add_u32 v5, 0x16000, v5
  ds_read_b128 v[144:147], v5 offset:0
  ds_read_b128 v[148:151], v5 offset:4096
  ds_read_b128 v[152:155], v5 offset:8192
  ds_read_b128 v[156:159], v5 offset:12288
  ds_read_b128 v[160:163], v5 offset:16384
  ds_read_b128 v[164:167], v5 offset:20480
  ds_read_b128 v[168:171], v5 offset:24576
  ds_read_b128 v[172:175], v5 offset:28672
  v_lshlrev_b32 v6, 4, v0
  s_lshl_b32 s24, s20, 2
  s_add_u32 s24, s24, s21
  s_lshl_b32 s24, s24, 15
  s_add_u32 s24, s24, 0x500000
  s_waitcnt lgkmcnt(7)
  buffer_store_dwordx4 v[144:147], v6, s[16:19], s24 offen
  s_add_u32 s24, s24, 4096
  s_waitcnt lgkmcnt(6)
  buffer_store_dwordx4 v[148:151], v6, s[16:19], s24 offen
  s_add_u32 s24, s24, 4096
  s_waitcnt lgkmcnt(5)
  buffer_store_dwordx4 v[152:155], v6, s[16:19], s24 offen
  s_add_u32 s24, s24, 4096
  s_waitcnt lgkmcnt(4)
  buffer_store_dwordx4 v[156:159], v6, s[16:19], s24 offen
  s_add_u32 s24, s24, 4096
  s_waitcnt lgkmcnt(3)
  buffer_store_dwordx4 v[160:163], v6, s[16:19], s24 offen
  s_add_u32 s24, s24, 4096
  s_waitcnt lgkmcnt(2)
  buffer_store_dwordx4 v[164:167], v6, s[16:19], s24 offen
  s_add_u32 s24, s24, 4096
  s_waitcnt lgkmcnt(1)
  buffer_store_dwordx4 v[168:171], v6, s[16:19], s24 offen
  s_add_u32 s24, s24, 4096
  s_waitcnt lgkmcnt(0)
  buffer_store_dwordx4 v[172:175], v6, s[16:19], s24 offen
  s_add_u32 s24, s24, 4096
  s_branch B_done
B_nyq:
  v_lshlrev_b32 v5, 2, v2
  v_lshl_add_u32 v5, v3, 9, v5
  s_mov_b32 s24, 0x900000
  s_nop 7
  s_nop 7
  buffer_store_dword v144, v5, s[16:19], s24 offen offset:0
  buffer_store_dword v145, v5, s[16:19], s24 offen offset:128
  buffer_store_dword v146, v5, s[16:19], s24 offen offset:256
  buffer_store_dword v147, v5, s[16:19], s24 offen offset:384
  buffer_store_dword v148, v5, s[16:19], s24 offen offset:1024
  buffer_store_dword v149, v5, s[16:19], s24 offen offset:1152
  buffer_store_dword v150, v5, s[16:19], s24 offen offset:1280
  buffer_store_dword v151, v5, s[16:19], s24 offen offset:1408
  buffer_store_dword v152, v5, s[16:19], s24 offen offset:2048
  buffer_store_dword v153, v5, s[16:19], s24 offen offset:2176
  buffer_store_dword v154, v5, s[16:19], s24 offen offset:2304
  buffer_store_dword v155, v5, s[16:19], s24 offen offset:2432
  buffer_store_dword v156, v5, s[16:19], s24 offen offset:3072
  buffer_store_dword v157, v5, s[16:19], s24 offen offset:3200
  buffer_store_dword v158, v5, s[16:19], s24 offen offset:3328
  buffer_store_dword v159, v5, s[16:19], s24 offen offset:3456
  s_add_u32 s24, s24, 4096
  buffer_store_dword v160, v5, s[16:19], s24 offen offset:0
  buffer_store_dword v161, v5, s[16:19], s24 offen offset:128
  buffer_store_dword v162, v5, s[16:19], s24 offen offset:256
  buffer_store_dword v163, v5, s[16:19], s24 offen offset:384
  buffer_store_dword v164, v5, s[16:19], s24 offen offset:1024
  buffer_store_dword v165, v5, s[16:19], s24 offen offset:1152
  buffer_store_dword v166, v5, s[16:19], s24 offen offset:1280
  buffer_store_dword v167, v5, s[16:19], s24 offen offset:1408
  buffer_store_dword v168, v5, s[16:19], s24 offen offset:2048
  buffer_store_dword v169, v5, s[16:19], s24 offen offset:2176
  buffer_store_dword v170, v5, s[16:19], s24 offen offset:2304
  buffer_store_dword v171, v5, s[16:19], s24 offen offset:2432
  buffer_store_dword v172, v5, s[16:19], s24 offen offset:3072
  buffer_store_dword v173, v5, s[16:19], s24 offen offset:3200
  buffer_store_dword v174, v5, s[16:19], s24 offen offset:3328
  buffer_store_dword v175, v5, s[16:19], s24 offen offset:3456
  s_add_u32 s24, s24, 4096
  s_branch B_done
B_pref:
  s_load_dwordx2 s[4:5], s[0:1], 32
  v_and_b32 v1, 63, v0
  v_lshrrev_b32 v5, 6, v0
  s_nop 0
  v_readfirstlane_b32 s3, v5
  s_waitcnt lgkmcnt(0)
  s_mov_b32 s12, s4
  s_and_b32 s13, s5, 0xffff
  s_mov_b32 s14, 0x700000
  s_mov_b32 s15, 0x00020000
  s_sub_u32 s25, s2, 129
  s_and_b32 s24, s2, 7
  s_lshr_b32 s26, s25, 3
  s_mul_i32 s26, s26, 4
  s_add_u32 s26, s26, s3
  s_mul_i32 s26, s26, 229376
  s_mul_i32 s27, s24, 896
  s_add_u32 s26, s26, s27
  v_min_u32 v2, 55, v1
  v_lshlrev_b32 v2, 4, v2
  buffer_load_dwordx4 v[8:11], v2, s[12:15], s26 offen
  s_add_u32 s26, s26, 7168
  buffer_load_dwordx4 v[8:11], v2, s[12:15], s26 offen
  s_add_u32 s26, s26, 7168
  buffer_load_dwordx4 v[8:11], v2, s[12:15], s26 offen
  s_add_u32 s26, s26, 7168
  buffer_load_dwordx4 v[8:11], v2, s[12:15], s26 offen
  s_add_u32 s26, s26, 7168
  buffer_load_dwordx4 v[8:11], v2, s[12:15], s26 offen
  s_add_u32 s26, s26, 7168
  buffer_load_dwordx4 v[8:11], v2, s[12:15], s26 offen
  s_add_u32 s26, s26, 7168
  buffer_load_dwordx4 v[8:11], v2, s[12:15], s26 offen
  s_add_u32 s26, s26, 7168
  buffer_load_dwordx4 v[8:11], v2, s[12:15], s26 offen
  s_add_u32 s26, s26, 7168
  buffer_load_dwordx4 v[8:11], v2, s[12:15], s26 offen
  s_add_u32 s26, s26, 7168
  buffer_load_dwordx4 v[8:11], v2, s[12:15], s26 offen
  s_add_u32 s26, s26, 7168
  buffer_load_dwordx4 v[8:11], v2, s[12:15], s26 offen
  s_add_u32 s26, s26, 7168
  buffer_load_dwordx4 v[8:11], v2, s[12:15], s26 offen
  s_add_u32 s26, s26, 7168
  buffer_load_dwordx4 v[8:11], v2, s[12:15], s26 offen
  s_add_u32 s26, s26, 7168
  buffer_load_dwordx4 v[8:11], v2, s[12:15], s26 offen
  s_add_u32 s26, s26, 7168
  buffer_load_dwordx4 v[8:11], v2, s[12:15], s26 offen
  s_add_u32 s26, s26, 7168
  buffer_load_dwordx4 v[8:11], v2, s[12:15], s26 offen
  s_add_u32 s26, s26, 7168
  buffer_load_dwordx4 v[8:11], v2, s[12:15], s26 offen
  s_add_u32 s26, s26, 7168
  buffer_load_dwordx4 v[8:11], v2, s[12:15], s26 offen
  s_add_u32 s26, s26, 7168
  buffer_load_dwordx4 v[8:11], v2, s[12:15], s26 offen
  s_add_u32 s26, s26, 7168
  buffer_load_dwordx4 v[8:11], v2, s[12:15], s26 offen
  s_add_u32 s26, s26, 7168
  buffer_load_dwordx4 v[8:11], v2, s[12:15], s26 offen
  s_add_u32 s26, s26, 7168
  buffer_load_dwordx4 v[8:11], v2, s[12:15], s26 offen
  s_add_u32 s26, s26, 7168
  buffer_load_dwordx4 v[8:11], v2, s[12:15], s26 offen
  s_add_u32 s26, s26, 7168
  buffer_load_dwordx4 v[8:11], v2, s[12:15], s26 offen
  s_add_u32 s26, s26, 7168
  buffer_load_dwordx4 v[8:11], v2, s[12:15], s26 offen
  s_add_u32 s26, s26, 7168
  buffer_load_dwordx4 v[8:11], v2, s[12:15], s26 offen
  s_add_u32 s26, s26, 7168
  buffer_load_dwordx4 v[8:11], v2, s[12:15], s26 offen
  s_add_u32 s26, s26, 7168
  buffer_load_dwordx4 v[8:11], v2, s[12:15], s26 offen
  s_add_u32 s26, s26, 7168
  buffer_load_dwordx4 v[8:11], v2, s[12:15], s26 offen
  s_add_u32 s26, s26, 7168
  buffer_load_dwordx4 v[8:11], v2, s[12:15], s26 offen
  s_add_u32 s26, s26, 7168
  buffer_load_dwordx4 v[8:11], v2, s[12:15], s26 offen
  s_add_u32 s26, s26, 7168
  buffer_load_dwordx4 v[8:11], v2, s[12:15], s26 offen
  s_add_u32 s26, s26, 7168
  s_waitcnt vmcnt(0)
B_done:
B_done2:
  s_endpgm
.globl fftC_kernel
.p2align 8
.type fftC_kernel,@function
fftC_kernel:
  s_cmp_ge_u32 s2, 256
  s_cbranch_scc1 C_done
  s_cmp_ge_u32 s2, 256
  s_cbranch_scc1 C_pref
  s_load_dwordx2 s[4:5], s[0:1], 0
  s_load_dwordx2 s[10:11], s[0:1], 72
  v_and_b32 v1, 63, v0
  v_lshrrev_b32 v5, 6, v0
  s_nop 0
  v_readfirstlane_b32 s3, v5
  v_and_b32 v2, 15, v1
  v_lshrrev_b32 v3, 4, v1
  v_lshlrev_b32 v4, 4, v1
  s_waitcnt lgkmcnt(0)
  s_mov_b32 s12, s4
  s_and_b32 s13, s5, 0xffff
  s_mov_b32 s14, 0x400000
  s_mov_b32 s15, 0x00020000
  s_mov_b32 s16, s10
  s_and_b32 s17, s11, 0xffff
  s_mov_b32 s18, 0x10000000
  s_mov_b32 s19, 0x00020000
  s_lshl_b32 s24, s3, 11
  s_add_u32 s25, s24, 0xf16000
  s_mov_b32 m0, s24
  s_nop 0
  buffer_load_dwordx4 v4, s[16:19], s25 offen lds
  s_add_u32 s24, s24, 1024
  s_add_u32 s25, s25, 1024
  s_mov_b32 m0, s24
  s_nop 0
  buffer_load_dwordx4 v4, s[16:19], s25 offen lds
  s_add_u32 s24, s24, 1024
  s_add_u32 s25, s25, 1024
  s_lshl_b32 s20, s2, 3
  s_add_u32 s20, s20, s3
  s_lshl_b32 s21, s20, 11
  v_lshlrev_b32 v5, 17, v2
  v_lshl_add_u32 v5, v3, 15, v5
  s_lshl_b32 s22, s20, 4
  s_add_u32 s22, s22, 0x500000
  s_add_u32 s23, s22, 0x200000
  buffer_load_dwordx4 v[8:11], v5, s[16:19], s22 offen
  buffer_load_dwordx4 v[12:15], v5, s[16:19], s23 offen
  s_lshl_b32 s23, s20, 2
  s_add_u32 s23, s23, 0x900000
  v_mov_b32 v17, 0
  buffer_load_dword v16, v17, s[16:19], s23 offen
  v_lshlrev_b32 v6, 6, v2
  v_lshl_add_u32 v6, v3, 3, v6
  buffer_load_dwordx2 v[84:85], v6, s[12:15], s21 offen offset:0
  buffer_load_dwordx2 v[86:87], v6, s[12:15], s21 offen offset:1024
  buffer_load_dwordx2 v[88:89], v6, s[12:15], s21 offen offset:32
  buffer_load_dwordx2 v[90:91], v6, s[12:15], s21 offen offset:1056
  s_waitcnt vmcnt(7)
  s_barrier
  ds_read_b128 v[20:23], v4 offset:0
  ds_read_b128 v[24:27], v4 offset:1024
  ds_read_b128 v[28:31], v4 offset:2048
  ds_read_b128 v[32:35], v4 offset:3072
  ds_read_b128 v[36:39], v4 offset:4096
  ds_read_b128 v[40:43], v4 offset:5120
  ds_read_b128 v[44:47], v4 offset:6144
  ds_read_b128 v[48:51], v4 offset:7168
  ds_read_b128 v[52:55], v4 offset:8192
  ds_read_b128 v[56:59], v4 offset:9216
  ds_read_b128 v[60:63], v4 offset:10240
  ds_read_b128 v[64:67], v4 offset:11264
  ds_read_b128 v[68:71], v4 offset:12288
  ds_read_b128 v[72:75], v4 offset:13312
  ds_read_b128 v[76:79], v4 offset:14336
  ds_read_b128 v[80:83], v4 offset:15360
  s_waitcnt vmcnt(4) lgkmcnt(12)
  v_mfma_f32_16x16x32_bf16 v[92:95], v[8:11], v[20:23], 0
  v_mfma_f32_16x16x32_bf16 v[108:111], v[8:11], v[28:31], 0
  v_mfma_f32_16x16x32_bf16 v[96:99], v[8:11], v[24:27], 0
  v_mfma_f32_16x16x32_bf16 v[112:115], v[8:11], v[32:35], 0
  v_mfma_f32_16x16x32_bf16 v[100:103], v[12:15], v[20:23], 0
  v_mfma_f32_16x16x32_bf16 v[116:119], v[12:15], v[28:31], 0
  v_mfma_f32_16x16x32_bf16 v[104:107], v[12:15], v[24:27], 0
  v_mfma_f32_16x16x32_bf16 v[120:123], v[12:15], v[32:35], 0
  v_lshlrev_b32 v17, 31, v2
  v_xor_b32 v16, v16, v17
  v_cmp_eq_u32 vcc, 0, v3
  s_nop 1
  v_cndmask_b32 v16, 0, v16, vcc
  v_add_f32 v92, v92, v16
  v_add_f32 v96, v96, v16
  s_waitcnt lgkmcnt(4)
  v_pk_mul_f32 v[124:125], v[92:93], v[36:37]
  v_pk_mul_f32 v[126:127], v[108:109], v[36:37]
  v_pk_fma_f32 v[124:125], v[108:109], v[38:39], v[124:125] neg_lo:[1,0,0] neg_hi:[1,0,0]
  v_pk_fma_f32 v[126:127], v[92:93], v[38:39], v[126:127]
  v_cvt_pk_bf16_f32 v128, v124, v125
  v_cvt_pk_bf16_f32 v136, v126, v127
  v_pk_mul_f32 v[124:125], v[94:95], v[40:41]
  v_pk_mul_f32 v[126:127], v[110:111], v[40:41]
  v_pk_fma_f32 v[124:125], v[110:111], v[42:43], v[124:125] neg_lo:[1,0,0] neg_hi:[1,0,0]
  v_pk_fma_f32 v[126:127], v[94:95], v[42:43], v[126:127]
  v_cvt_pk_bf16_f32 v129, v124, v125
  v_cvt_pk_bf16_f32 v137, v126, v127
  v_pk_mul_f32 v[124:125], v[96:97], v[44:45]
  v_pk_mul_f32 v[126:127], v[112:113], v[44:45]
  v_pk_fma_f32 v[124:125], v[112:113], v[46:47], v[124:125] neg_lo:[1,0,0] neg_hi:[1,0,0]
  v_pk_fma_f32 v[126:127], v[96:97], v[46:47], v[126:127]
  v_cvt_pk_bf16_f32 v132, v124, v125
  v_cvt_pk_bf16_f32 v140, v126, v127
  v_pk_mul_f32 v[124:125], v[98:99], v[48:49]
  v_pk_mul_f32 v[126:127], v[114:115], v[48:49]
  v_pk_fma_f32 v[124:125], v[114:115], v[50:51], v[124:125] neg_lo:[1,0,0] neg_hi:[1,0,0]
  v_pk_fma_f32 v[126:127], v[98:99], v[50:51], v[126:127]
  v_cvt_pk_bf16_f32 v133, v124, v125
  v_cvt_pk_bf16_f32 v141, v126, v127
  v_pk_mul_f32 v[124:125], v[100:101], v[52:53]
  v_pk_mul_f32 v[126:127], v[116:117], v[52:53]
  v_pk_fma_f32 v[124:125], v[116:117], v[54:55], v[124:125] neg_lo:[1,0,0] neg_hi:[1,0,0]
  v_pk_fma_f32 v[126:127], v[100:101], v[54:55], v[126:127]
  v_cvt_pk_bf16_f32 v130, v124, v125
  v_cvt_pk_bf16_f32 v138, v126, v127
  v_pk_mul_f32 v[124:125], v[102:103], v[56:57]
  v_pk_mul_f32 v[126:127], v[118:119], v[56:57]
  v_pk_fma_f32 v[124:125], v[118:119], v[58:59], v[124:125] neg_lo:[1,0,0] neg_hi:[1,0,0]
  v_pk_fma_f32 v[126:127], v[102:103], v[58:59], v[126:127]
  v_cvt_pk_bf16_f32 v131, v124, v125
  v_cvt_pk_bf16_f32 v139, v126, v127
  v_pk_mul_f32 v[124:125], v[104:105], v[60:61]
  v_pk_mul_f32 v[126:127], v[120:121], v[60:61]
  v_pk_fma_f32 v[124:125], v[120:121], v[62:63], v[124:125] neg_lo:[1,0,0] neg_hi:[1,0,0]
  v_pk_fma_f32 v[126:127], v[104:105], v[62:63], v[126:127]
  v_cvt_pk_bf16_f32 v134, v124, v125
  v_cvt_pk_bf16_f32 v142, v126, v127
  v_pk_mul_f32 v[124:125], v[106:107], v[64:65]
  v_pk_mul_f32 v[126:127], v[122:123], v[64:65]
  v_pk_fma_f32 v[124:125], v[122:123], v[66:67], v[124:125] neg_lo:[1,0,0] neg_hi:[1,0,0]
  v_pk_fma_f32 v[126:127], v[106:107], v[66:67], v[126:127]
  v_cvt_pk_bf16_f32 v135, v124, v125
  v_cvt_pk_bf16_f32 v143, v126, v127
  s_waitcnt lgkmcnt(0)
  v_mfma_f32_16x16x32_bf16 v[92:95], v[128:131], v[68:71], 0
  v_mfma_f32_16x16x32_bf16 v[92:95], v[136:139], v[76:79], v[92:95]
  v_mfma_f32_16x16x32_bf16 v[96:99], v[128:131], v[72:75], 0
  v_mfma_f32_16x16x32_bf16 v[96:99], v[136:139], v[80:83], v[96:99]
  v_mfma_f32_16x16x32_bf16 v[100:103], v[132:135], v[68:71], 0
  v_mfma_f32_16x16x32_bf16 v[100:103], v[140:143], v[76:79], v[100:103]
  v_mfma_f32_16x16x32_bf16 v[104:107], v[132:135], v[72:75], 0
  v_mfma_f32_16x16x32_bf16 v[104:107], v[140:143], v[80:83], v[104:107]
  s_waitcnt vmcnt(0)
  s_nop 0
  v_cvt_pk_bf16_f32 v124, v92, v93
  v_lshlrev_b32 v125, 16, v124
  v_and_b32 v126, 0xffff0000, v124
  v_lshlrev_b32 v127, 16, v84
  v_add_f32 v125, v125, v127
  v_and_b32 v127, 0xffff0000, v84
  v_add_f32 v126, v126, v127
  v_cvt_pk_bf16_f32 v144, v125, v126
  v_lshlrev_b32 v108, 16, v144
  v_and_b32 v109, 0xffff0000, v144
  v_cvt_pk_bf16_f32 v124, v94, v95
  v_lshlrev_b32 v125, 16, v124
  v_and_b32 v126, 0xffff0000, v124
  v_lshlrev_b32 v127, 16, v85
  v_add_f32 v125, v125, v127
  v_and_b32 v127, 0xffff0000, v85
  v_add_f32 v126, v126, v127
  v_cvt_pk_bf16_f32 v145, v125, v126
  v_lshlrev_b32 v110, 16, v145
  v_and_b32 v111, 0xffff0000, v145
  v_cvt_pk_bf16_f32 v124, v96, v97
  v_lshlrev_b32 v125, 16, v124
  v_and_b32 v126, 0xffff0000, v124
  v_lshlrev_b32 v127, 16, v86
  v_add_f32 v125, v125, v127
  v_and_b32 v127, 0xffff0000, v86
  v_add_f32 v126, v126, v127
  v_cvt_pk_bf16_f32 v146, v125, v126
  v_lshlrev_b32 v112, 16, v146
  v_and_b32 v113, 0xffff0000, v146
  v_cvt_pk_bf16_f32 v124, v98, v99
  v_lshlrev_b32 v125, 16, v124
  v_and_b32 v126, 0xffff0000, v124
  v_lshlrev_b32 v127, 16, v87
  v_add_f32 v125, v125, v127
  v_and_b32 v127, 0xffff0000, v87
  v_add_f32 v126, v126, v127
  v_cvt_pk_bf16_f32 v147, v125, v126
  v_lshlrev_b32 v114, 16, v147
  v_and_b32 v115, 0xffff0000, v147
  v_cvt_pk_bf16_f32 v124, v100, v101
  v_lshlrev_b32 v125, 16, v124
  v_and_b32 v126, 0xffff0000, v124
  v_lshlrev_b32 v127, 16, v88
  v_add_f32 v125, v125, v127
  v_and_b32 v127, 0xffff0000, v88
  v_add_f32 v126, v126, v127
  v_cvt_pk_bf16_f32 v148, v125, v126
  v_lshlrev_b32 v116, 16, v148
  v_and_b32 v117, 0xffff0000, v148
  v_cvt_pk_bf16_f32 v124, v102, v103
  v_lshlrev_b32 v125, 16, v124
  v_and_b32 v126, 0xffff0000, v124
  v_lshlrev_b32 v127, 16, v89
  v_add_f32 v125, v125, v127
  v_and_b32 v127, 0xffff0000, v89
  v_add_f32 v126, v126, v127
  v_cvt_pk_bf16_f32 v149, v125, v126
  v_lshlrev_b32 v118, 16, v149
  v_and_b32 v119, 0xffff0000, v149
  v_cvt_pk_bf16_f32 v124, v104, v105
  v_lshlrev_b32 v125, 16, v124
  v_and_b32 v126, 0xffff0000, v124
  v_lshlrev_b32 v127, 16, v90
  v_add_f32 v125, v125, v127
  v_and_b32 v127, 0xffff0000, v90
  v_add_f32 v126, v126, v127
  v_cvt_pk_bf16_f32 v150, v125, v126
  v_lshlrev_b32 v120, 16, v150
  v_and_b32 v121, 0xffff0000, v150
  v_cvt_pk_bf16_f32 v124, v106, v107
  v_lshlrev_b32 v125, 16, v124
  v_and_b32 v126, 0xffff0000, v124
  v_lshlrev_b32 v127, 16, v91
  v_add_f32 v125, v125, v127
  v_and_b32 v127, 0xffff0000, v91
  v_add_f32 v126, v126, v127
  v_cvt_pk_bf16_f32 v151, v125, v126
  v_lshlrev_b32 v122, 16, v151
  v_and_b32 v123, 0xffff0000, v151
  s_add_u32 s22, s21, 0x1000000
  buffer_store_dwordx2 v[144:145], v6, s[16:19], s22 offen offset:0
  buffer_store_dwordx2 v[146:147], v6, s[16:19], s22 offen offset:1024
  buffer_store_dwordx2 v[148:149], v6, s[16:19], s22 offen offset:32
  buffer_store_dwordx2 v[150:151], v6, s[16:19], s22 offen offset:1056
  v_add_f32 v152, v108, v109
  v_add_f32 v152, v152, v110
  v_add_f32 v152, v152, v111
  v_add_f32 v152, v152, v112
  v_add_f32 v152, v152, v113
  v_add_f32 v152, v152, v114
  v_add_f32 v152, v152, v115
  v_add_f32 v152, v152, v116
  v_add_f32 v152, v152, v117
  v_add_f32 v152, v152, v118
  v_add_f32 v152, v152, v119
  v_add_f32 v152, v152, v120
  v_add_f32 v152, v152, v121
  v_add_f32 v152, v152, v122
  v_add_f32 v152, v152, v123
  ds_swizzle_b32 v153, v152 offset:0x041F
  s_waitcnt lgkmcnt(0)
  v_add_f32 v152, v152, v153
  ds_swizzle_b32 v153, v152 offset:0x081F
  s_waitcnt lgkmcnt(0)
  v_add_f32 v152, v152, v153
  ds_swizzle_b32 v153, v152 offset:0x101F
  s_waitcnt lgkmcnt(0)
  v_add_f32 v152, v152, v153
  ds_swizzle_b32 v153, v152 offset:0x201F
  s_waitcnt lgkmcnt(0)
  v_add_f32 v152, v152, v153
  ds_swizzle_b32 v153, v152 offset:0x401F
  s_waitcnt lgkmcnt(0)
  v_add_f32 v152, v152, v153
  s_nop 0
  v_readlane_b32 s24, v152, 0
  v_readlane_b32 s25, v152, 32
  s_nop 0
  v_mov_b32 v152, s24
  v_add_f32 v152, s25, v152
  v_mul_f32 v152, 0x3a800000, v152
  v_sub_f32 v92, v108, v152
  v_sub_f32 v93, v109, v152
  v_sub_f32 v94, v110, v152
  v_sub_f32 v95, v111, v152
  v_sub_f32 v96, v112, v152
  v_sub_f32 v97, v113, v152
  v_sub_f32 v98, v114, v152
  v_sub_f32 v99, v115, v152
  v_sub_f32 v100, v116, v152
  v_sub_f32 v101, v117, v152
  v_sub_f32 v102, v118, v152
  v_sub_f32 v103, v119, v152
  v_sub_f32 v104, v120, v152
  v_sub_f32 v105, v121, v152
  v_sub_f32 v106, v122, v152
  v_sub_f32 v107, v123, v152
  v_mul_f32 v154, v92, v92
  v_fmac_f32 v154, v93, v93
  v_fmac_f32 v154, v94, v94
  v_fmac_f32 v154, v95, v95
  v_fmac_f32 v154, v96, v96
  v_fmac_f32 v154, v97, v97
  v_fmac_f32 v154, v98, v98
  v_fmac_f32 v154, v99, v99
  v_fmac_f32 v154, v100, v100
  v_fmac_f32 v154, v101, v101
  v_fmac_f32 v154, v102, v102
  v_fmac_f32 v154, v103, v103
  v_fmac_f32 v154, v104, v104
  v_fmac_f32 v154, v105, v105
  v_fmac_f32 v154, v106, v106
  v_fmac_f32 v154, v107, v107
  ds_swizzle_b32 v155, v154 offset:0x041F
  s_waitcnt lgkmcnt(0)
  v_add_f32 v154, v154, v155
  ds_swizzle_b32 v155, v154 offset:0x081F
  s_waitcnt lgkmcnt(0)
  v_add_f32 v154, v154, v155
  ds_swizzle_b32 v155, v154 offset:0x101F
  s_waitcnt lgkmcnt(0)
  v_add_f32 v154, v154, v155
  ds_swizzle_b32 v155, v154 offset:0x201F
  s_waitcnt lgkmcnt(0)
  v_add_f32 v154, v154, v155
  ds_swizzle_b32 v155, v154 offset:0x401F
  s_waitcnt lgkmcnt(0)
  v_add_f32 v154, v154, v155
  s_nop 0
  v_readlane_b32 s24, v154, 0
  v_readlane_b32 s25, v154, 32
  s_nop 0
  v_mov_b32 v154, s24
  v_add_f32 v154, s25, v154
  v_mul_f32 v154, 0x3a800000, v154
  v_cvt_pk_bf16_f32 v153, v152, v154
  v_lshlrev_b32 v152, 16, v153
  v_and_b32 v154, 0xffff0000, v153
  v_add_f32 v154, 0x3727c5ac, v154
  v_cvt_pk_bf16_f32 v154, v154, v154
  v_and_b32 v154, 0xffff0000, v154
  v_sqrt_f32 v154, v154
  s_nop 0
  v_cvt_pk_bf16_f32 v154, v154, v154
  v_and_b32 v154, 0xffff0000, v154
  v_rcp_f32 v154, v154
  v_sub_f32 v92, v108, v152
  v_sub_f32 v93, v109, v152
  v_cvt_pk_bf16_f32 v124, v92, v93
  v_lshlrev_b32 v92, 16, v124
  v_and_b32 v93, 0xffff0000, v124
  v_mul_f32 v92, v92, v154
  v_mul_f32 v93, v93, v154
  v_cvt_pk_bf16_f32 v128, v92, v93
  v_sub_f32 v94, v110, v152
  v_sub_f32 v95, v111, v152
  v_cvt_pk_bf16_f32 v124, v94, v95
  v_lshlrev_b32 v94, 16, v124
  v_and_b32 v95, 0xffff0000, v124
  v_mul_f32 v94, v94, v154
  v_mul_f32 v95, v95, v154
  v_cvt_pk_bf16_f32 v129, v94, v95
  v_sub_f32 v96, v112, v152
  v_sub_f32 v97, v113, v152
  v_cvt_pk_bf16_f32 v124, v96, v97
  v_lshlrev_b32 v96, 16, v124
  v_and_b32 v97, 0xffff0000, v124
  v_mul_f32 v96, v96, v154
  v_mul_f32 v97, v97, v154
  v_cvt_pk_bf16_f32 v130, v96, v97
  v_sub_f32 v98, v114, v152
  v_sub_f32 v99, v115, v152
  v_cvt_pk_bf16_f32 v124, v98, v99
  v_lshlrev_b32 v98, 16, v124
  v_and_b32 v99, 0xffff0000, v124
  v_mul_f32 v98, v98, v154
  v_mul_f32 v99, v99, v154
  v_cvt_pk_bf16_f32 v131, v98, v99
  v_sub_f32 v100, v116, v152
  v_sub_f32 v101, v117, v152
  v_cvt_pk_bf16_f32 v124, v100, v101
  v_lshlrev_b32 v100, 16, v124
  v_and_b32 v101, 0xffff0000, v124
  v_mul_f32 v100, v100, v154
  v_mul_f32 v101, v101, v154
  v_cvt_pk_bf16_f32 v132, v100, v101
  v_sub_f32 v102, v118, v152
  v_sub_f32 v103, v119, v152
  v_cvt_pk_bf16_f32 v124, v102, v103
  v_lshlrev_b32 v102, 16, v124
  v_and_b32 v103, 0xffff0000, v124
  v_mul_f32 v102, v102, v154
  v_mul_f32 v103, v103, v154
  v_cvt_pk_bf16_f32 v133, v102, v103
  v_sub_f32 v104, v120, v152
  v_sub_f32 v105, v121, v152
  v_cvt_pk_bf16_f32 v124, v104, v105
  v_lshlrev_b32 v104, 16, v124
  v_and_b32 v105, 0xffff0000, v124
  v_mul_f32 v104, v104, v154
  v_mul_f32 v105, v105, v154
  v_cvt_pk_bf16_f32 v134, v104, v105
  v_sub_f32 v106, v122, v152
  v_sub_f32 v107, v123, v152
  v_cvt_pk_bf16_f32 v124, v106, v107
  v_lshlrev_b32 v106, 16, v124
  v_and_b32 v107, 0xffff0000, v124
  v_mul_f32 v106, v106, v154
  v_mul_f32 v107, v107, v154
  v_cvt_pk_bf16_f32 v135, v106, v107
  s_lshr_b32 s22, s20, 4
  s_lshl_b32 s22, s22, 15
  s_and_b32 s23, s20, 15
  s_lshl_b32 s23, s23, 4
  s_add_u32 s22, s22, s23
  s_add_u32 s22, s22, 0x1400000
  s_add_u32 s23, s22, 16384
  v_lshrrev_b32 v5, 1, v3
  v_lshlrev_b32 v5, 8, v5
  v_lshl_add_u32 v5, v2, 10, v5
  v_and_b32 v7, 1, v3
  v_lshl_add_u32 v5, v7, 3, v5
  buffer_store_dwordx2 v[128:129], v5, s[16:19], s22 offen offset:0
  buffer_store_dwordx2 v[130:131], v5, s[16:19], s23 offen offset:0
  buffer_store_dwordx2 v[132:133], v5, s[16:19], s22 offen offset:512
  buffer_store_dwordx2 v[134:135], v5, s[16:19], s23 offen offset:512
  s_branch C_done
C_pref:
  s_load_dwordx2 s[4:5], s[0:1], 40
  v_and_b32 v1, 63, v0
  v_lshrrev_b32 v5, 6, v0
  s_nop 0
  v_readfirstlane_b32 s3, v5
  s_waitcnt lgkmcnt(0)
  s_mov_b32 s12, s4
  s_and_b32 s13, s5, 0xffff
  s_mov_b32 s14, 0x700000
  s_mov_b32 s15, 0x00020000
  s_sub_u32 s25, s2, 256
  s_and_b32 s24, s2, 7
  s_lshr_b32 s26, s25, 3
  s_mul_i32 s26, s26, 8
  s_add_u32 s26, s26, s3
  s_mul_i32 s26, s26, 114688
  s_mul_i32 s27, s24, 896
  s_add_u32 s26, s26, s27
  v_min_u32 v2, 55, v1
  v_lshlrev_b32 v2, 4, v2
  buffer_load_dwordx4 v[8:11], v2, s[12:15], s26 offen
  s_add_u32 s26, s26, 7168
  buffer_load_dwordx4 v[8:11], v2, s[12:15], s26 offen
  s_add_u32 s26, s26, 7168
  buffer_load_dwordx4 v[8:11], v2, s[12:15], s26 offen
  s_add_u32 s26, s26, 7168
  buffer_load_dwordx4 v[8:11], v2, s[12:15], s26 offen
  s_add_u32 s26, s26, 7168
  buffer_load_dwordx4 v[8:11], v2, s[12:15], s26 offen
  s_add_u32 s26, s26, 7168
  buffer_load_dwordx4 v[8:11], v2, s[12:15], s26 offen
  s_add_u32 s26, s26, 7168
  buffer_load_dwordx4 v[8:11], v2, s[12:15], s26 offen
  s_add_u32 s26, s26, 7168
  buffer_load_dwordx4 v[8:11], v2, s[12:15], s26 offen
  s_add_u32 s26, s26, 7168
  buffer_load_dwordx4 v[8:11], v2, s[12:15], s26 offen
  s_add_u32 s26, s26, 7168
  buffer_load_dwordx4 v[8:11], v2, s[12:15], s26 offen
  s_add_u32 s26, s26, 7168
  buffer_load_dwordx4 v[8:11], v2, s[12:15], s26 offen
  s_add_u32 s26, s26, 7168
  buffer_load_dwordx4 v[8:11], v2, s[12:15], s26 offen
  s_add_u32 s26, s26, 7168
  buffer_load_dwordx4 v[8:11], v2, s[12:15], s26 offen
  s_add_u32 s26, s26, 7168
  buffer_load_dwordx4 v[8:11], v2, s[12:15], s26 offen
  s_add_u32 s26, s26, 7168
  buffer_load_dwordx4 v[8:11], v2, s[12:15], s26 offen
  s_add_u32 s26, s26, 7168
  buffer_load_dwordx4 v[8:11], v2, s[12:15], s26 offen
  s_add_u32 s26, s26, 7168
  s_waitcnt vmcnt(0)
C_done:
C_done2:
  s_endpgm
.globl ffn1_kernel
.p2align 8
.type ffn1_kernel,@function
ffn1_kernel:
  s_cmp_ge_u32 s2, 256
  s_cbranch_scc1 G1_done
  s_load_dwordx4 s[4:7], s[0:1], 32
  s_load_dwordx2 s[10:11], s[0:1], 72
  v_and_b32 v1, 63, v0
  v_lshrrev_b32 v5, 6, v0
  s_nop 0
  v_readfirstlane_b32 s24, v5
  v_and_b32 v2, 15, v1
  v_lshrrev_b32 v3, 4, v1
  s_waitcnt lgkmcnt(0)
  s_cmp_ge_u32 s24, 4
  s_cselect_b32 s4, s6, s4
  s_cselect_b32 s5, s7, s5
  s_mov_b32 s12, s4
  s_and_b32 s13, s5, 0xffff
  s_mov_b32 s14, 0x700000
  s_mov_b32 s15, 0x00020000
  s_mov_b32 s20, s10
  s_and_b32 s21, s11, 0xffff
  s_mov_b32 s22, 0x10000000
  s_mov_b32 s23, 0x00020000
  s_and_b32 s3, s2, 7
  s_lshr_b32 s8, s2, 3
  s_and_b32 s9, s8, 3
  s_lshl_b32 s3, s3, 2
  s_add_u32 s3, s3, s9
  s_lshr_b32 s8, s8, 2
  s_mul_i32 s9, s3, 112
  s_lshl_b32 s29, s8, 8
  s_mul_i32 s27, s24, 32
  s_add_u32 s29, s29, s27
  s_lshl_b32 s26, s29, 11
  s_add_u32 s26, s26, 0x1400000
  s_mov_b32 s25, 0
  v_lshlrev_b32 v92, 4, v1
  v_add_u32 v93, 0x8000, v92
  v_lshrrev_b32 v36, 1, v2
  v_and_b32 v37, 1, v2
  s_and_b32 s27, s24, 3
  s_and_b32 s28, s24, 1
  s_lshl_b32 s28, s28, 2
  s_lshl_b32 s27, s27, 3
  v_or_b32 v38, s28, v3
  v_xor_b32 v38, v38, v36
  v_min_u32 v38, 6, v38
  v_lshlrev_b32 v38, 4, v38
  v_lshl_add_u32 v38, v37, 3, v38
  v_add_u32 v38, s9, v38
  v_lshlrev_b32 v38, 1, v38
  v_add_u32 v39, 0, v3
  v_add_u32 v39, s27, v39
  v_mul_u32_u24 v39, 7168, v39
  v_add_u32 v94, v38, v39
  v_or_b32 v38, s28, v3
  v_xor_b32 v38, v38, v36
  v_min_u32 v38, 6, v38
  v_lshlrev_b32 v38, 4, v38
  v_lshl_add_u32 v38, v37, 3, v38
  v_add_u32 v38, s9, v38
  v_lshlrev_b32 v38, 1, v38
  v_add_u32 v39, 4, v3
  v_add_u32 v39, s27, v39
  v_mul_u32_u24 v39, 7168, v39
  v_add_u32 v95, v38, v39
  s_lshl_b32 s28, s24, 11
  v_lshrrev_b32 v36, 2, v1
  v_and_b32 v36, 3, v36
  v_and_b32 v37, 1, v3
  v_lshl_or_b32 v37, v37, 2, v36
  v_lshl_add_u32 v38, v3, 3, v36
  v_lshlrev_b32 v38, 8, v38
  v_and_b32 v39, 3, v1
  v_lshl_add_u32 v38, v39, 3, v38
  v_xor_b32 v39, 0, v37
  v_lshl_add_u32 v96, v39, 5, v38
  v_xor_b32 v39, 1, v37
  v_lshl_add_u32 v97, v39, 5, v38
  v_xor_b32 v39, 2, v37
  v_lshl_add_u32 v98, v39, 5, v38
  v_xor_b32 v39, 3, v37
  v_lshl_add_u32 v99, v39, 5, v38
  v_xor_b32 v39, 4, v37
  v_lshl_add_u32 v100, v39, 5, v38
  v_xor_b32 v39, 5, v37
  v_lshl_add_u32 v101, v39, 5, v38
  v_xor_b32 v39, 6, v37
  v_lshl_add_u32 v102, v39, 5, v38
  s_add_u32 m0, s28, 0
  s_nop 0
  buffer_load_dwordx4 v94, s[12:15], s25 offen lds
  s_add_u32 m0, s28, 1024
  s_nop 0
  buffer_load_dwordx4 v95, s[12:15], s25 offen lds
  buffer_load_dwordx4 v[4:7], v92, s[20:23], s26 offen
  buffer_load_dwordx4 v[8:11], v93, s[20:23], s26 offen
  s_add_u32 s25, s25, 229376
  s_add_u32 s26, s26, 1024
  s_add_u32 m0, s28, 16384
  s_nop 0
  buffer_load_dwordx4 v94, s[12:15], s25 offen lds
  s_add_u32 m0, s28, 17408
  s_nop 0
  buffer_load_dwordx4 v95, s[12:15], s25 offen lds
  buffer_load_dwordx4 v[12:15], v92, s[20:23], s26 offen
  buffer_load_dwordx4 v[16:19], v93, s[20:23], s26 offen
  s_add_u32 s25, s25, 229376
  s_add_u32 s26, s26, 1024
  s_add_u32 m0, s28, 32768
  s_nop 0
  buffer_load_dwordx4 v94, s[12:15], s25 offen lds
  s_add_u32 m0, s28, 33792
  s_nop 0
  buffer_load_dwordx4 v95, s[12:15], s25 offen lds
  buffer_load_dwordx4 v[20:23], v92, s[20:23], s26 offen
  buffer_load_dwordx4 v[24:27], v93, s[20:23], s26 offen
  s_add_u32 s25, s25, 229376
  s_add_u32 s26, s26, 1024
  v_accvgpr_write_b32 a0, 0
  v_accvgpr_write_b32 a1, 0
  v_accvgpr_write_b32 a2, 0
  v_accvgpr_write_b32 a3, 0
  v_accvgpr_write_b32 a4, 0
  v_accvgpr_write_b32 a5, 0
  v_accvgpr_write_b32 a6, 0
  v_accvgpr_write_b32 a7, 0
  v_accvgpr_write_b32 a8, 0
  v_accvgpr_write_b32 a9, 0
  v_accvgpr_write_b32 a10, 0
  v_accvgpr_write_b32 a11, 0
  v_accvgpr_write_b32 a12, 0
  v_accvgpr_write_b32 a13, 0
  v_accvgpr_write_b32 a14, 0
  v_accvgpr_write_b32 a15, 0
  v_accvgpr_write_b32 a16, 0
  v_accvgpr_write_b32 a17, 0
  v_accvgpr_write_b32 a18, 0
  v_accvgpr_write_b32 a19, 0
  v_accvgpr_write_b32 a20, 0
  v_accvgpr_write_b32 a21, 0
  v_accvgpr_write_b32 a22, 0
  v_accvgpr_write_b32 a23, 0
  v_accvgpr_write_b32 a24, 0
  v_accvgpr_write_b32 a25, 0
  v_accvgpr_write_b32 a26, 0
  v_accvgpr_write_b32 a27, 0
  v_accvgpr_write_b32 a28, 0
  v_accvgpr_write_b32 a29, 0
  v_accvgpr_write_b32 a30, 0
  v_accvgpr_write_b32 a31, 0
  v_accvgpr_write_b32 a32, 0
  v_accvgpr_write_b32 a33, 0
  v_accvgpr_write_b32 a34, 0
  v_accvgpr_write_b32 a35, 0
  v_accvgpr_write_b32 a36, 0
  v_accvgpr_write_b32 a37, 0
  v_accvgpr_write_b32 a38, 0
  v_accvgpr_write_b32 a39, 0
  v_accvgpr_write_b32 a40, 0
  v_accvgpr_write_b32 a41, 0
  v_accvgpr_write_b32 a42, 0
  v_accvgpr_write_b32 a43, 0
  v_accvgpr_write_b32 a44, 0
  v_accvgpr_write_b32 a45, 0
  v_accvgpr_write_b32 a46, 0
  v_accvgpr_write_b32 a47, 0
  v_accvgpr_write_b32 a48, 0
  v_accvgpr_write_b32 a49, 0
  v_accvgpr_write_b32 a50, 0
  v_accvgpr_write_b32 a51, 0
  v_accvgpr_write_b32 a52, 0
  v_accvgpr_write_b32 a53, 0
  v_accvgpr_write_b32 a54, 0
  v_accvgpr_write_b32 a55, 0
  v_accvgpr_write_b32 a56, 0
  v_accvgpr_write_b32 a57, 0
  v_accvgpr_write_b32 a58, 0
  v_accvgpr_write_b32 a59, 0
  v_accvgpr_write_b32 a60, 0
  v_accvgpr_write_b32 a61, 0
  v_accvgpr_write_b32 a62, 0
  v_accvgpr_write_b32 a63, 0
  v_accvgpr_write_b32 a64, 0
  v_accvgpr_write_b32 a65, 0
  v_accvgpr_write_b32 a66, 0
  v_accvgpr_write_b32 a67, 0
  v_accvgpr_write_b32 a68, 0
  v_accvgpr_write_b32 a69, 0
  v_accvgpr_write_b32 a70, 0
  v_accvgpr_write_b32 a71, 0
  v_accvgpr_write_b32 a72, 0
  v_accvgpr_write_b32 a73, 0
  v_accvgpr_write_b32 a74, 0
  v_accvgpr_write_b32 a75, 0
  v_accvgpr_write_b32 a76, 0
  v_accvgpr_write_b32 a77, 0
  v_accvgpr_write_b32 a78, 0
  v_accvgpr_write_b32 a79, 0
  v_accvgpr_write_b32 a80, 0
  v_accvgpr_write_b32 a81, 0
  v_accvgpr_write_b32 a82, 0
  v_accvgpr_write_b32 a83, 0
  v_accvgpr_write_b32 a84, 0
  v_accvgpr_write_b32 a85, 0
  v_accvgpr_write_b32 a86, 0
  v_accvgpr_write_b32 a87, 0
  v_accvgpr_write_b32 a88, 0
  v_accvgpr_write_b32 a89, 0
  v_accvgpr_write_b32 a90, 0
  v_accvgpr_write_b32 a91, 0
  v_accvgpr_write_b32 a92, 0
  v_accvgpr_write_b32 a93, 0
  v_accvgpr_write_b32 a94, 0
  v_accvgpr_write_b32 a95, 0
  v_accvgpr_write_b32 a96, 0
  v_accvgpr_write_b32 a97, 0
  v_accvgpr_write_b32 a98, 0
  v_accvgpr_write_b32 a99, 0
  v_accvgpr_write_b32 a100, 0
  v_accvgpr_write_b32 a101, 0
  v_accvgpr_write_b32 a102, 0
  v_accvgpr_write_b32 a103, 0
  v_accvgpr_write_b32 a104, 0
  v_accvgpr_write_b32 a105, 0
  v_accvgpr_write_b32 a106, 0
  v_accvgpr_write_b32 a107, 0
  v_accvgpr_write_b32 a108, 0
  v_accvgpr_write_b32 a109, 0
  v_accvgpr_write_b32 a110, 0
  v_accvgpr_write_b32 a111, 0
  s_waitcnt vmcnt(10)
  s_barrier
  ds_read_b64_tr_b16 v[36:37], v96 offset:0
  ds_read_b64_tr_b16 v[38:39], v96 offset:1024
  ds_read_b64_tr_b16 v[40:41], v97 offset:0
  ds_read_b64_tr_b16 v[42:43], v97 offset:1024
  ds_read_b64_tr_b16 v[44:45], v98 offset:0
  ds_read_b64_tr_b16 v[46:47], v98 offset:1024
  ds_read_b64_tr_b16 v[48:49], v99 offset:0
  ds_read_b64_tr_b16 v[50:51], v99 offset:1024
  ds_read_b64_tr_b16 v[52:53], v100 offset:0
  ds_read_b64_tr_b16 v[54:55], v100 offset:1024
  ds_read_b64_tr_b16 v[56:57], v101 offset:0
  ds_read_b64_tr_b16 v[58:59], v101 offset:1024
  ds_read_b64_tr_b16 v[60:61], v102 offset:0
  ds_read_b64_tr_b16 v[62:63], v102 offset:1024
  s_mov_b32 s27, 0
G1_loop:
  s_waitcnt vmcnt(6)
  s_barrier
  s_waitcnt lgkmcnt(0)
  v_mfma_f32_16x16x32_bf16 a[0:3], v[36:39], v[4:7], a[0:3]
  ds_read_b64_tr_b16 v[64:65], v96 offset:8192
  v_mfma_f32_16x16x32_bf16 a[8:11], v[40:43], v[4:7], a[8:11]
  ds_read_b64_tr_b16 v[66:67], v96 offset:9216
  v_mfma_f32_16x16x32_bf16 a[16:19], v[44:47], v[4:7], a[16:19]
  ds_read_b64_tr_b16 v[68:69], v97 offset:8192
  v_mfma_f32_16x16x32_bf16 a[24:27], v[48:51], v[4:7], a[24:27]
  ds_read_b64_tr_b16 v[70:71], v97 offset:9216
  s_add_u32 m0, s28, 49152
  s_nop 0
  buffer_load_dwordx4 v94, s[12:15], s25 offen lds
  v_mfma_f32_16x16x32_bf16 a[32:35], v[52:55], v[4:7], a[32:35]
  ds_read_b64_tr_b16 v[72:73], v98 offset:8192
  v_mfma_f32_16x16x32_bf16 a[40:43], v[56:59], v[4:7], a[40:43]
  ds_read_b64_tr_b16 v[74:75], v98 offset:9216
  v_mfma_f32_16x16x32_bf16 a[48:51], v[60:63], v[4:7], a[48:51]
  ds_read_b64_tr_b16 v[76:77], v99 offset:8192
  v_mfma_f32_16x16x32_bf16 a[4:7], v[36:39], v[8:11], a[4:7]
  ds_read_b64_tr_b16 v[78:79], v99 offset:9216
  v_mfma_f32_16x16x32_bf16 a[12:15], v[40:43], v[8:11], a[12:15]
  ds_read_b64_tr_b16 v[80:81], v100 offset:8192
  v_mfma_f32_16x16x32_bf16 a[20:23], v[44:47], v[8:11], a[20:23]
  ds_read_b64_tr_b16 v[82:83], v100 offset:9216
  v_mfma_f32_16x16x32_bf16 a[28:31], v[48:51], v[8:11], a[28:31]
  ds_read_b64_tr_b16 v[84:85], v101 offset:8192
  s_add_u32 m0, s28, 50176
  s_nop 0
  buffer_load_dwordx4 v95, s[12:15], s25 offen lds
  v_mfma_f32_16x16x32_bf16 a[36:39], v[52:55], v[8:11], a[36:39]
  ds_read_b64_tr_b16 v[86:87], v101 offset:9216
  v_mfma_f32_16x16x32_bf16 a[44:47], v[56:59], v[8:11], a[44:47]
  ds_read_b64_tr_b16 v[88:89], v102 offset:8192
  v_mfma_f32_16x16x32_bf16 a[52:55], v[60:63], v[8:11], a[52:55]
  ds_read_b64_tr_b16 v[90:91], v102 offset:9216
  s_waitcnt lgkmcnt(0)
  v_mfma_f32_16x16x32_bf16 a[56:59], v[64:67], v[4:7], a[56:59]
  ds_read_b64_tr_b16 v[36:37], v96 offset:16384
  v_mfma_f32_16x16x32_bf16 a[64:67], v[68:71], v[4:7], a[64:67]
  ds_read_b64_tr_b16 v[38:39], v96 offset:17408
  v_mfma_f32_16x16x32_bf16 a[72:75], v[72:75], v[4:7], a[72:75]
  ds_read_b64_tr_b16 v[40:41], v97 offset:16384
  v_mfma_f32_16x16x32_bf16 a[80:83], v[76:79], v[4:7], a[80:83]
  ds_read_b64_tr_b16 v[42:43], v97 offset:17408
  buffer_load_dwordx4 v[28:31], v92, s[20:23], s26 offen
  v_mfma_f32_16x16x32_bf16 a[88:91], v[80:83], v[4:7], a[88:91]
  ds_read_b64_tr_b16 v[44:45], v98 offset:16384
  v_mfma_f32_16x16x32_bf16 a[96:99], v[84:87], v[4:7], a[96:99]
  ds_read_b64_tr_b16 v[46:47], v98 offset:17408
  v_mfma_f32_16x16x32_bf16 a[104:107], v[88:91], v[4:7], a[104:107]
  ds_read_b64_tr_b16 v[48:49], v99 offset:16384
  v_mfma_f32_16x16x32_bf16 a[60:63], v[64:67], v[8:11], a[60:63]
  ds_read_b64_tr_b16 v[50:51], v99 offset:17408
  v_mfma_f32_16x16x32_bf16 a[68:71], v[68:71], v[8:11], a[68:71]
  ds_read_b64_tr_b16 v[52:53], v100 offset:16384
  v_mfma_f32_16x16x32_bf16 a[76:79], v[72:75], v[8:11], a[76:79]
  ds_read_b64_tr_b16 v[54:55], v100 offset:17408
  v_mfma_f32_16x16x32_bf16 a[84:87], v[76:79], v[8:11], a[84:87]
  ds_read_b64_tr_b16 v[56:57], v101 offset:16384
  buffer_load_dwordx4 v[32:35], v93, s[20:23], s26 offen
  s_add_u32 s25, s25, 229376
  s_add_u32 s26, s26, 1024
  v_mfma_f32_16x16x32_bf16 a[92:95], v[80:83], v[8:11], a[92:95]
  ds_read_b64_tr_b16 v[58:59], v101 offset:17408
  v_mfma_f32_16x16x32_bf16 a[100:103], v[84:87], v[8:11], a[100:103]
  ds_read_b64_tr_b16 v[60:61], v102 offset:16384
  v_mfma_f32_16x16x32_bf16 a[108:111], v[88:91], v[8:11], a[108:111]
  ds_read_b64_tr_b16 v[62:63], v102 offset:17408
  s_waitcnt vmcnt(6)
  s_barrier
  s_waitcnt lgkmcnt(0)
  v_mfma_f32_16x16x32_bf16 a[0:3], v[36:39], v[12:15], a[0:3]
  ds_read_b64_tr_b16 v[64:65], v96 offset:24576
  v_mfma_f32_16x16x32_bf16 a[8:11], v[40:43], v[12:15], a[8:11]
  ds_read_b64_tr_b16 v[66:67], v96 offset:25600
  v_mfma_f32_16x16x32_bf16 a[16:19], v[44:47], v[12:15], a[16:19]
  ds_read_b64_tr_b16 v[68:69], v97 offset:24576
  v_mfma_f32_16x16x32_bf16 a[24:27], v[48:51], v[12:15], a[24:27]
  ds_read_b64_tr_b16 v[70:71], v97 offset:25600
  s_add_u32 m0, s28, 0
  s_nop 0
  buffer_load_dwordx4 v94, s[12:15], s25 offen lds
  v_mfma_f32_16x16x32_bf16 a[32:35], v[52:55], v[12:15], a[32:35]
  ds_read_b64_tr_b16 v[72:73], v98 offset:24576
  v_mfma_f32_16x16x32_bf16 a[40:43], v[56:59], v[12:15], a[40:43]
  ds_read_b64_tr_b16 v[74:75], v98 offset:25600
  v_mfma_f32_16x16x32_bf16 a[48:51], v[60:63], v[12:15], a[48:51]
  ds_read_b64_tr_b16 v[76:77], v99 offset:24576
  v_mfma_f32_16x16x32_bf16 a[4:7], v[36:39], v[16:19], a[4:7]
  ds_read_b64_tr_b16 v[78:79], v99 offset:25600
  v_mfma_f32_16x16x32_bf16 a[12:15], v[40:43], v[16:19], a[12:15]
  ds_read_b64_tr_b16 v[80:81], v100 offset:24576
  v_mfma_f32_16x16x32_bf16 a[20:23], v[44:47], v[16:19], a[20:23]
  ds_read_b64_tr_b16 v[82:83], v100 offset:25600
  v_mfma_f32_16x16x32_bf16 a[28:31], v[48:51], v[16:19], a[28:31]
  ds_read_b64_tr_b16 v[84:85], v101 offset:24576
  s_add_u32 m0, s28, 1024
  s_nop 0
  buffer_load_dwordx4 v95, s[12:15], s25 offen lds
  v_mfma_f32_16x16x32_bf16 a[36:39], v[52:55], v[16:19], a[36:39]
  ds_read_b64_tr_b16 v[86:87], v101 offset:25600
  v_mfma_f32_16x16x32_bf16 a[44:47], v[56:59], v[16:19], a[44:47]
  ds_read_b64_tr_b16 v[88:89], v102 offset:24576
  v_mfma_f32_16x16x32_bf16 a[52:55], v[60:63], v[16:19], a[52:55]
  ds_read_b64_tr_b16 v[90:91], v102 offset:25600
  s_waitcnt lgkmcnt(0)
  v_mfma_f32_16x16x32_bf16 a[56:59], v[64:67], v[12:15], a[56:59]
  ds_read_b64_tr_b16 v[36:37], v96 offset:32768
  v_mfma_f32_16x16x32_bf16 a[64:67], v[68:71], v[12:15], a[64:67]
  ds_read_b64_tr_b16 v[38:39], v96 offset:33792
  v_mfma_f32_16x16x32_bf16 a[72:75], v[72:75], v[12:15], a[72:75]
  ds_read_b64_tr_b16 v[40:41], v97 offset:32768
  v_mfma_f32_16x16x32_bf16 a[80:83], v[76:79], v[12:15], a[80:83]
  ds_read_b64_tr_b16 v[42:43], v97 offset:33792
  buffer_load_dwordx4 v[4:7], v92, s[20:23], s26 offen
  v_mfma_f32_16x16x32_bf16 a[88:91], v[80:83], v[12:15], a[88:91]
  ds_read_b64_tr_b16 v[44:45], v98 offset:32768
  v_mfma_f32_16x16x32_bf16 a[96:99], v[84:87], v[12:15], a[96:99]
  ds_read_b64_tr_b16 v[46:47], v98 offset:33792
  v_mfma_f32_16x16x32_bf16 a[104:107], v[88:91], v[12:15], a[104:107]
  ds_read_b64_tr_b16 v[48:49], v99 offset:32768
  v_mfma_f32_16x16x32_bf16 a[60:63], v[64:67], v[16:19], a[60:63]
  ds_read_b64_tr_b16 v[50:51], v99 offset:33792
  v_mfma_f32_16x16x32_bf16 a[68:71], v[68:71], v[16:19], a[68:71]
  ds_read_b64_tr_b16 v[52:53], v100 offset:32768
  v_mfma_f32_16x16x32_bf16 a[76:79], v[72:75], v[16:19], a[76:79]
  ds_read_b64_tr_b16 v[54:55], v100 offset:33792
  v_mfma_f32_16x16x32_bf16 a[84:87], v[76:79], v[16:19], a[84:87]
  ds_read_b64_tr_b16 v[56:57], v101 offset:32768
  buffer_load_dwordx4 v[8:11], v93, s[20:23], s26 offen
  s_add_u32 s25, s25, 229376
  s_add_u32 s26, s26, 1024
  v_mfma_f32_16x16x32_bf16 a[92:95], v[80:83], v[16:19], a[92:95]
  ds_read_b64_tr_b16 v[58:59], v101 offset:33792
  v_mfma_f32_16x16x32_bf16 a[100:103], v[84:87], v[16:19], a[100:103]
  ds_read_b64_tr_b16 v[60:61], v102 offset:32768
  v_mfma_f32_16x16x32_bf16 a[108:111], v[88:91], v[16:19], a[108:111]
  ds_read_b64_tr_b16 v[62:63], v102 offset:33792
  s_waitcnt vmcnt(6)
  s_barrier
  s_waitcnt lgkmcnt(0)
  v_mfma_f32_16x16x32_bf16 a[0:3], v[36:39], v[20:23], a[0:3]
  ds_read_b64_tr_b16 v[64:65], v96 offset:40960
  v_mfma_f32_16x16x32_bf16 a[8:11], v[40:43], v[20:23], a[8:11]
  ds_read_b64_tr_b16 v[66:67], v96 offset:41984
  v_mfma_f32_16x16x32_bf16 a[16:19], v[44:47], v[20:23], a[16:19]
  ds_read_b64_tr_b16 v[68:69], v97 offset:40960
  v_mfma_f32_16x16x32_bf16 a[24:27], v[48:51], v[20:23], a[24:27]
  ds_read_b64_tr_b16 v[70:71], v97 offset:41984
  s_add_u32 m0, s28, 16384
  s_nop 0
  buffer_load_dwordx4 v94, s[12:15], s25 offen lds
  v_mfma_f32_16x16x32_bf16 a[32:35], v[52:55], v[20:23], a[32:35]
  ds_read_b64_tr_b16 v[72:73], v98 offset:40960
  v_mfma_f32_16x16x32_bf16 a[40:43], v[56:59], v[20:23], a[40:43]
  ds_read_b64_tr_b16 v[74:75], v98 offset:41984
  v_mfma_f32_16x16x32_bf16 a[48:51], v[60:63], v[20:23], a[48:51]
  ds_read_b64_tr_b16 v[76:77], v99 offset:40960
  v_mfma_f32_16x16x32_bf16 a[4:7], v[36:39], v[24:27], a[4:7]
  ds_read_b64_tr_b16 v[78:79], v99 offset:41984
  v_mfma_f32_16x16x32_bf16 a[12:15], v[40:43], v[24:27], a[12:15]
  ds_read_b64_tr_b16 v[80:81], v100 offset:40960
  v_mfma_f32_16x16x32_bf16 a[20:23], v[44:47], v[24:27], a[20:23]
  ds_read_b64_tr_b16 v[82:83], v100 offset:41984
  v_mfma_f32_16x16x32_bf16 a[28:31], v[48:51], v[24:27], a[28:31]
  ds_read_b64_tr_b16 v[84:85], v101 offset:40960
  s_add_u32 m0, s28, 17408
  s_nop 0
  buffer_load_dwordx4 v95, s[12:15], s25 offen lds
  v_mfma_f32_16x16x32_bf16 a[36:39], v[52:55], v[24:27], a[36:39]
  ds_read_b64_tr_b16 v[86:87], v101 offset:41984
  v_mfma_f32_16x16x32_bf16 a[44:47], v[56:59], v[24:27], a[44:47]
  ds_read_b64_tr_b16 v[88:89], v102 offset:40960
  v_mfma_f32_16x16x32_bf16 a[52:55], v[60:63], v[24:27], a[52:55]
  ds_read_b64_tr_b16 v[90:91], v102 offset:41984
  s_waitcnt lgkmcnt(0)
  v_mfma_f32_16x16x32_bf16 a[56:59], v[64:67], v[20:23], a[56:59]
  ds_read_b64_tr_b16 v[36:37], v96 offset:49152
  v_mfma_f32_16x16x32_bf16 a[64:67], v[68:71], v[20:23], a[64:67]
  ds_read_b64_tr_b16 v[38:39], v96 offset:50176
  v_mfma_f32_16x16x32_bf16 a[72:75], v[72:75], v[20:23], a[72:75]
  ds_read_b64_tr_b16 v[40:41], v97 offset:49152
  v_mfma_f32_16x16x32_bf16 a[80:83], v[76:79], v[20:23], a[80:83]
  ds_read_b64_tr_b16 v[42:43], v97 offset:50176
  buffer_load_dwordx4 v[12:15], v92, s[20:23], s26 offen
  v_mfma_f32_16x16x32_bf16 a[88:91], v[80:83], v[20:23], a[88:91]
  ds_read_b64_tr_b16 v[44:45], v98 offset:49152
  v_mfma_f32_16x16x32_bf16 a[96:99], v[84:87], v[20:23], a[96:99]
  ds_read_b64_tr_b16 v[46:47], v98 offset:50176
  v_mfma_f32_16x16x32_bf16 a[104:107], v[88:91], v[20:23], a[104:107]
  ds_read_b64_tr_b16 v[48:49], v99 offset:49152
  v_mfma_f32_16x16x32_bf16 a[60:63], v[64:67], v[24:27], a[60:63]
  ds_read_b64_tr_b16 v[50:51], v99 offset:50176
  v_mfma_f32_16x16x32_bf16 a[68:71], v[68:71], v[24:27], a[68:71]
  ds_read_b64_tr_b16 v[52:53], v100 offset:49152
  v_mfma_f32_16x16x32_bf16 a[76:79], v[72:75], v[24:27], a[76:79]
  ds_read_b64_tr_b16 v[54:55], v100 offset:50176
  v_mfma_f32_16x16x32_bf16 a[84:87], v[76:79], v[24:27], a[84:87]
  ds_read_b64_tr_b16 v[56:57], v101 offset:49152
  buffer_load_dwordx4 v[16:19], v93, s[20:23], s26 offen
  s_add_u32 s25, s25, 229376
  s_add_u32 s26, s26, 1024
  v_mfma_f32_16x16x32_bf16 a[92:95], v[80:83], v[24:27], a[92:95]
  ds_read_b64_tr_b16 v[58:59], v101 offset:50176
  v_mfma_f32_16x16x32_bf16 a[100:103], v[84:87], v[24:27], a[100:103]
  ds_read_b64_tr_b16 v[60:61], v102 offset:49152
  v_mfma_f32_16x16x32_bf16 a[108:111], v[88:91], v[24:27], a[108:111]
  ds_read_b64_tr_b16 v[62:63], v102 offset:50176
  s_waitcnt vmcnt(6)
  s_barrier
  s_waitcnt lgkmcnt(0)
  v_mfma_f32_16x16x32_bf16 a[0:3], v[36:39], v[28:31], a[0:3]
  ds_read_b64_tr_b16 v[64:65], v96 offset:57344
  v_mfma_f32_16x16x32_bf16 a[8:11], v[40:43], v[28:31], a[8:11]
  ds_read_b64_tr_b16 v[66:67], v96 offset:58368
  v_mfma_f32_16x16x32_bf16 a[16:19], v[44:47], v[28:31], a[16:19]
  ds_read_b64_tr_b16 v[68:69], v97 offset:57344
  v_mfma_f32_16x16x32_bf16 a[24:27], v[48:51], v[28:31], a[24:27]
  ds_read_b64_tr_b16 v[70:71], v97 offset:58368
  s_add_u32 m0, s28, 32768
  s_nop 0
  buffer_load_dwordx4 v94, s[12:15], s25 offen lds
  v_mfma_f32_16x16x32_bf16 a[32:35], v[52:55], v[28:31], a[32:35]
  ds_read_b64_tr_b16 v[72:73], v98 offset:57344
  v_mfma_f32_16x16x32_bf16 a[40:43], v[56:59], v[28:31], a[40:43]
  ds_read_b64_tr_b16 v[74:75], v98 offset:58368
  v_mfma_f32_16x16x32_bf16 a[48:51], v[60:63], v[28:31], a[48:51]
  ds_read_b64_tr_b16 v[76:77], v99 offset:57344
  v_mfma_f32_16x16x32_bf16 a[4:7], v[36:39], v[32:35], a[4:7]
  ds_read_b64_tr_b16 v[78:79], v99 offset:58368
  v_mfma_f32_16x16x32_bf16 a[12:15], v[40:43], v[32:35], a[12:15]
  ds_read_b64_tr_b16 v[80:81], v100 offset:57344
  v_mfma_f32_16x16x32_bf16 a[20:23], v[44:47], v[32:35], a[20:23]
  ds_read_b64_tr_b16 v[82:83], v100 offset:58368
  v_mfma_f32_16x16x32_bf16 a[28:31], v[48:51], v[32:35], a[28:31]
  ds_read_b64_tr_b16 v[84:85], v101 offset:57344
  s_add_u32 m0, s28, 33792
  s_nop 0
  buffer_load_dwordx4 v95, s[12:15], s25 offen lds
  v_mfma_f32_16x16x32_bf16 a[36:39], v[52:55], v[32:35], a[36:39]
  ds_read_b64_tr_b16 v[86:87], v101 offset:58368
  v_mfma_f32_16x16x32_bf16 a[44:47], v[56:59], v[32:35], a[44:47]
  ds_read_b64_tr_b16 v[88:89], v102 offset:57344
  v_mfma_f32_16x16x32_bf16 a[52:55], v[60:63], v[32:35], a[52:55]
  ds_read_b64_tr_b16 v[90:91], v102 offset:58368
  s_waitcnt lgkmcnt(0)
  v_mfma_f32_16x16x32_bf16 a[56:59], v[64:67], v[28:31], a[56:59]
  ds_read_b64_tr_b16 v[36:37], v96 offset:0
  v_mfma_f32_16x16x32_bf16 a[64:67], v[68:71], v[28:31], a[64:67]
  ds_read_b64_tr_b16 v[38:39], v96 offset:1024
  v_mfma_f32_16x16x32_bf16 a[72:75], v[72:75], v[28:31], a[72:75]
  ds_read_b64_tr_b16 v[40:41], v97 offset:0
  v_mfma_f32_16x16x32_bf16 a[80:83], v[76:79], v[28:31], a[80:83]
  ds_read_b64_tr_b16 v[42:43], v97 offset:1024
  buffer_load_dwordx4 v[20:23], v92, s[20:23], s26 offen
  v_mfma_f32_16x16x32_bf16 a[88:91], v[80:83], v[28:31], a[88:91]
  ds_read_b64_tr_b16 v[44:45], v98 offset:0
  v_mfma_f32_16x16x32_bf16 a[96:99], v[84:87], v[28:31], a[96:99]
  ds_read_b64_tr_b16 v[46:47], v98 offset:1024
  v_mfma_f32_16x16x32_bf16 a[104:107], v[88:91], v[28:31], a[104:107]
  ds_read_b64_tr_b16 v[48:49], v99 offset:0
  v_mfma_f32_16x16x32_bf16 a[60:63], v[64:67], v[32:35], a[60:63]
  ds_read_b64_tr_b16 v[50:51], v99 offset:1024
  v_mfma_f32_16x16x32_bf16 a[68:71], v[68:71], v[32:35], a[68:71]
  ds_read_b64_tr_b16 v[52:53], v100 offset:0
  v_mfma_f32_16x16x32_bf16 a[76:79], v[72:75], v[32:35], a[76:79]
  ds_read_b64_tr_b16 v[54:55], v100 offset:1024
  v_mfma_f32_16x16x32_bf16 a[84:87], v[76:79], v[32:35], a[84:87]
  ds_read_b64_tr_b16 v[56:57], v101 offset:0
  buffer_load_dwordx4 v[24:27], v93, s[20:23], s26 offen
  s_add_u32 s25, s25, 229376
  s_add_u32 s26, s26, 1024
  v_mfma_f32_16x16x32_bf16 a[92:95], v[80:83], v[32:35], a[92:95]
  ds_read_b64_tr_b16 v[58:59], v101 offset:1024
  v_mfma_f32_16x16x32_bf16 a[100:103], v[84:87], v[32:35], a[100:103]
  ds_read_b64_tr_b16 v[60:61], v102 offset:0
  v_mfma_f32_16x16x32_bf16 a[108:111], v[88:91], v[32:35], a[108:111]
  ds_read_b64_tr_b16 v[62:63], v102 offset:1024
  s_add_u32 s27, s27, 1
  s_cmp_lt_u32 s27, 8
  s_cbranch_scc1 G1_loop
  s_waitcnt vmcnt(0) lgkmcnt(0)
  s_mov_b32 s30, 0x3d372713
  s_mov_b32 s31, 0xc0135761
  v_lshrrev_b32 v92, 1, v3
  v_lshlrev_b32 v92, 8, v92
  v_lshl_add_u32 v92, v2, 4, v92
  v_and_b32 v93, 1, v3
  v_lshl_add_u32 v92, v93, 3, v92
  s_lshr_b32 s25, s29, 4
  s_mul_i32 s25, s25, 114688
  s_mul_i32 s26, s3, 3584
  s_add_u32 s25, s25, s26
  s_add_u32 s25, s25, 0x1800000
  s_nop 7
  v_accvgpr_read_b32 v4, a0
  v_accvgpr_read_b32 v8, a56
  v_accvgpr_read_b32 v5, a1
  v_accvgpr_read_b32 v9, a57
  v_accvgpr_read_b32 v6, a2
  v_accvgpr_read_b32 v10, a58
  v_accvgpr_read_b32 v7, a3
  v_accvgpr_read_b32 v11, a59
  v_cvt_pk_bf16_f32 v20, v4, v5
  v_cvt_pk_bf16_f32 v21, v8, v9
  v_lshlrev_b32 v4, 16, v20
  v_and_b32 v5, 0xffff0000, v20
  v_lshlrev_b32 v8, 16, v21
  v_and_b32 v9, 0xffff0000, v21
  v_mul_f32 v22, v4, v4
  v_fma_f32 v22, v22, s30, 1.0
  v_mul_f32 v22, v22, v4
  v_mul_f32 v22, s31, v22
  v_exp_f32 v22, v22
  v_mul_f32 v23, v5, v5
  v_fma_f32 v23, v23, s30, 1.0
  v_mul_f32 v23, v23, v5
  v_mul_f32 v23, s31, v23
  v_exp_f32 v23, v23
  v_add_f32 v22, 1.0, v22
  v_rcp_f32 v22, v22
  v_add_f32 v23, 1.0, v23
  v_rcp_f32 v23, v23
  v_mul_f32 v22, v22, v4
  v_mul_f32 v23, v23, v5
  v_cvt_pk_bf16_f32 v20, v22, v23
  v_lshlrev_b32 v22, 16, v20
  v_and_b32 v23, 0xffff0000, v20
  v_mul_f32 v22, v22, v8
  v_mul_f32 v23, v23, v9
  v_cvt_pk_bf16_f32 v12, v22, v23
  v_cvt_pk_bf16_f32 v20, v6, v7
  v_cvt_pk_bf16_f32 v21, v10, v11
  v_lshlrev_b32 v6, 16, v20
  v_and_b32 v7, 0xffff0000, v20
  v_lshlrev_b32 v10, 16, v21
  v_and_b32 v11, 0xffff0000, v21
  v_mul_f32 v22, v6, v6
  v_fma_f32 v22, v22, s30, 1.0
  v_mul_f32 v22, v22, v6
  v_mul_f32 v22, s31, v22
  v_exp_f32 v22, v22
  v_mul_f32 v23, v7, v7
  v_fma_f32 v23, v23, s30, 1.0
  v_mul_f32 v23, v23, v7
  v_mul_f32 v23, s31, v23
  v_exp_f32 v23, v23
  v_add_f32 v22, 1.0, v22
  v_rcp_f32 v22, v22
  v_add_f32 v23, 1.0, v23
  v_rcp_f32 v23, v23
  v_mul_f32 v22, v22, v6
  v_mul_f32 v23, v23, v7
  v_cvt_pk_bf16_f32 v20, v22, v23
  v_lshlrev_b32 v22, 16, v20
  v_and_b32 v23, 0xffff0000, v20
  v_mul_f32 v22, v22, v10
  v_mul_f32 v23, v23, v11
  v_cvt_pk_bf16_f32 v13, v22, v23
  buffer_store_dwordx2 v[12:13], v92, s[20:23], s25 offen offset:0 sc1
  v_accvgpr_read_b32 v4, a8
  v_accvgpr_read_b32 v8, a64
  v_accvgpr_read_b32 v5, a9
  v_accvgpr_read_b32 v9, a65
  v_accvgpr_read_b32 v6, a10
  v_accvgpr_read_b32 v10, a66
  v_accvgpr_read_b32 v7, a11
  v_accvgpr_read_b32 v11, a67
  v_cvt_pk_bf16_f32 v20, v4, v5
  v_cvt_pk_bf16_f32 v21, v8, v9
  v_lshlrev_b32 v4, 16, v20
  v_and_b32 v5, 0xffff0000, v20
  v_lshlrev_b32 v8, 16, v21
  v_and_b32 v9, 0xffff0000, v21
  v_mul_f32 v22, v4, v4
  v_fma_f32 v22, v22, s30, 1.0
  v_mul_f32 v22, v22, v4
  v_mul_f32 v22, s31, v22
  v_exp_f32 v22, v22
  v_mul_f32 v23, v5, v5
  v_fma_f32 v23, v23, s30, 1.0
  v_mul_f32 v23, v23, v5
  v_mul_f32 v23, s31, v23
  v_exp_f32 v23, v23
  v_add_f32 v22, 1.0, v22
  v_rcp_f32 v22, v22
  v_add_f32 v23, 1.0, v23
  v_rcp_f32 v23, v23
  v_mul_f32 v22, v22, v4
  v_mul_f32 v23, v23, v5
  v_cvt_pk_bf16_f32 v20, v22, v23
  v_lshlrev_b32 v22, 16, v20
  v_and_b32 v23, 0xffff0000, v20
  v_mul_f32 v22, v22, v8
  v_mul_f32 v23, v23, v9
  v_cvt_pk_bf16_f32 v14, v22, v23
  v_cvt_pk_bf16_f32 v20, v6, v7
  v_cvt_pk_bf16_f32 v21, v10, v11
  v_lshlrev_b32 v6, 16, v20
  v_and_b32 v7, 0xffff0000, v20
  v_lshlrev_b32 v10, 16, v21
  v_and_b32 v11, 0xffff0000, v21
  v_mul_f32 v22, v6, v6
  v_fma_f32 v22, v22, s30, 1.0
  v_mul_f32 v22, v22, v6
  v_mul_f32 v22, s31, v22
  v_exp_f32 v22, v22
  v_mul_f32 v23, v7, v7
  v_fma_f32 v23, v23, s30, 1.0
  v_mul_f32 v23, v23, v7
  v_mul_f32 v23, s31, v23
  v_exp_f32 v23, v23
  v_add_f32 v22, 1.0, v22
  v_rcp_f32 v22, v22
  v_add_f32 v23, 1.0, v23
  v_rcp_f32 v23, v23
  v_mul_f32 v22, v22, v6
  v_mul_f32 v23, v23, v7
  v_cvt_pk_bf16_f32 v20, v22, v23
  v_lshlrev_b32 v22, 16, v20
  v_and_b32 v23, 0xffff0000, v20
  v_mul_f32 v22, v22, v10
  v_mul_f32 v23, v23, v11
  v_cvt_pk_bf16_f32 v15, v22, v23
  buffer_store_dwordx2 v[14:15], v92, s[20:23], s25 offen offset:512 sc1
  v_accvgpr_read_b32 v4, a16
  v_accvgpr_read_b32 v8, a72
  v_accvgpr_read_b32 v5, a17
  v_accvgpr_read_b32 v9, a73
  v_accvgpr_read_b32 v6, a18
  v_accvgpr_read_b32 v10, a74
  v_accvgpr_read_b32 v7, a19
  v_accvgpr_read_b32 v11, a75
  v_cvt_pk_bf16_f32 v20, v4, v5
  v_cvt_pk_bf16_f32 v21, v8, v9
  v_lshlrev_b32 v4, 16, v20
  v_and_b32 v5, 0xffff0000, v20
  v_lshlrev_b32 v8, 16, v21
  v_and_b32 v9, 0xffff0000, v21
  v_mul_f32 v22, v4, v4
  v_fma_f32 v22, v22, s30, 1.0
  v_mul_f32 v22, v22, v4
  v_mul_f32 v22, s31, v22
  v_exp_f32 v22, v22
  v_mul_f32 v23, v5, v5
  v_fma_f32 v23, v23, s30, 1.0
  v_mul_f32 v23, v23, v5
  v_mul_f32 v23, s31, v23
  v_exp_f32 v23, v23
  v_add_f32 v22, 1.0, v22
  v_rcp_f32 v22, v22
  v_add_f32 v23, 1.0, v23
  v_rcp_f32 v23, v23
  v_mul_f32 v22, v22, v4
  v_mul_f32 v23, v23, v5
  v_cvt_pk_bf16_f32 v20, v22, v23
  v_lshlrev_b32 v22, 16, v20
  v_and_b32 v23, 0xffff0000, v20
  v_mul_f32 v22, v22, v8
  v_mul_f32 v23, v23, v9
  v_cvt_pk_bf16_f32 v12, v22, v23
  v_cvt_pk_bf16_f32 v20, v6, v7
  v_cvt_pk_bf16_f32 v21, v10, v11
  v_lshlrev_b32 v6, 16, v20
  v_and_b32 v7, 0xffff0000, v20
  v_lshlrev_b32 v10, 16, v21
  v_and_b32 v11, 0xffff0000, v21
  v_mul_f32 v22, v6, v6
  v_fma_f32 v22, v22, s30, 1.0
  v_mul_f32 v22, v22, v6
  v_mul_f32 v22, s31, v22
  v_exp_f32 v22, v22
  v_mul_f32 v23, v7, v7
  v_fma_f32 v23, v23, s30, 1.0
  v_mul_f32 v23, v23, v7
  v_mul_f32 v23, s31, v23
  v_exp_f32 v23, v23
  v_add_f32 v22, 1.0, v22
  v_rcp_f32 v22, v22
  v_add_f32 v23, 1.0, v23
  v_rcp_f32 v23, v23
  v_mul_f32 v22, v22, v6
  v_mul_f32 v23, v23, v7
  v_cvt_pk_bf16_f32 v20, v22, v23
  v_lshlrev_b32 v22, 16, v20
  v_and_b32 v23, 0xffff0000, v20
  v_mul_f32 v22, v22, v10
  v_mul_f32 v23, v23, v11
  v_cvt_pk_bf16_f32 v13, v22, v23
  buffer_store_dwordx2 v[12:13], v92, s[20:23], s25 offen offset:1024 sc1
  v_accvgpr_read_b32 v4, a24
  v_accvgpr_read_b32 v8, a80
  v_accvgpr_read_b32 v5, a25
  v_accvgpr_read_b32 v9, a81
  v_accvgpr_read_b32 v6, a26
  v_accvgpr_read_b32 v10, a82
  v_accvgpr_read_b32 v7, a27
  v_accvgpr_read_b32 v11, a83
  v_cvt_pk_bf16_f32 v20, v4, v5
  v_cvt_pk_bf16_f32 v21, v8, v9
  v_lshlrev_b32 v4, 16, v20
  v_and_b32 v5, 0xffff0000, v20
  v_lshlrev_b32 v8, 16, v21
  v_and_b32 v9, 0xffff0000, v21
  v_mul_f32 v22, v4, v4
  v_fma_f32 v22, v22, s30, 1.0
  v_mul_f32 v22, v22, v4
  v_mul_f32 v22, s31, v22
  v_exp_f32 v22, v22
  v_mul_f32 v23, v5, v5
  v_fma_f32 v23, v23, s30, 1.0
  v_mul_f32 v23, v23, v5
  v_mul_f32 v23, s31, v23
  v_exp_f32 v23, v23
  v_add_f32 v22, 1.0, v22
  v_rcp_f32 v22, v22
  v_add_f32 v23, 1.0, v23
  v_rcp_f32 v23, v23
  v_mul_f32 v22, v22, v4
  v_mul_f32 v23, v23, v5
  v_cvt_pk_bf16_f32 v20, v22, v23
  v_lshlrev_b32 v22, 16, v20
  v_and_b32 v23, 0xffff0000, v20
  v_mul_f32 v22, v22, v8
  v_mul_f32 v23, v23, v9
  v_cvt_pk_bf16_f32 v14, v22, v23
  v_cvt_pk_bf16_f32 v20, v6, v7
  v_cvt_pk_bf16_f32 v21, v10, v11
  v_lshlrev_b32 v6, 16, v20
  v_and_b32 v7, 0xffff0000, v20
  v_lshlrev_b32 v10, 16, v21
  v_and_b32 v11, 0xffff0000, v21
  v_mul_f32 v22, v6, v6
  v_fma_f32 v22, v22, s30, 1.0
  v_mul_f32 v22, v22, v6
  v_mul_f32 v22, s31, v22
  v_exp_f32 v22, v22
  v_mul_f32 v23, v7, v7
  v_fma_f32 v23, v23, s30, 1.0
  v_mul_f32 v23, v23, v7
  v_mul_f32 v23, s31, v23
  v_exp_f32 v23, v23
  v_add_f32 v22, 1.0, v22
  v_rcp_f32 v22, v22
  v_add_f32 v23, 1.0, v23
  v_rcp_f32 v23, v23
  v_mul_f32 v22, v22, v6
  v_mul_f32 v23, v23, v7
  v_cvt_pk_bf16_f32 v20, v22, v23
  v_lshlrev_b32 v22, 16, v20
  v_and_b32 v23, 0xffff0000, v20
  v_mul_f32 v22, v22, v10
  v_mul_f32 v23, v23, v11
  v_cvt_pk_bf16_f32 v15, v22, v23
  buffer_store_dwordx2 v[14:15], v92, s[20:23], s25 offen offset:1536 sc1
  v_accvgpr_read_b32 v4, a32
  v_accvgpr_read_b32 v8, a88
  v_accvgpr_read_b32 v5, a33
  v_accvgpr_read_b32 v9, a89
  v_accvgpr_read_b32 v6, a34
  v_accvgpr_read_b32 v10, a90
  v_accvgpr_read_b32 v7, a35
  v_accvgpr_read_b32 v11, a91
  v_cvt_pk_bf16_f32 v20, v4, v5
  v_cvt_pk_bf16_f32 v21, v8, v9
  v_lshlrev_b32 v4, 16, v20
  v_and_b32 v5, 0xffff0000, v20
  v_lshlrev_b32 v8, 16, v21
  v_and_b32 v9, 0xffff0000, v21
  v_mul_f32 v22, v4, v4
  v_fma_f32 v22, v22, s30, 1.0
  v_mul_f32 v22, v22, v4
  v_mul_f32 v22, s31, v22
  v_exp_f32 v22, v22
  v_mul_f32 v23, v5, v5
  v_fma_f32 v23, v23, s30, 1.0
  v_mul_f32 v23, v23, v5
  v_mul_f32 v23, s31, v23
  v_exp_f32 v23, v23
  v_add_f32 v22, 1.0, v22
  v_rcp_f32 v22, v22
  v_add_f32 v23, 1.0, v23
  v_rcp_f32 v23, v23
  v_mul_f32 v22, v22, v4
  v_mul_f32 v23, v23, v5
  v_cvt_pk_bf16_f32 v20, v22, v23
  v_lshlrev_b32 v22, 16, v20
  v_and_b32 v23, 0xffff0000, v20
  v_mul_f32 v22, v22, v8
  v_mul_f32 v23, v23, v9
  v_cvt_pk_bf16_f32 v12, v22, v23
  v_cvt_pk_bf16_f32 v20, v6, v7
  v_cvt_pk_bf16_f32 v21, v10, v11
  v_lshlrev_b32 v6, 16, v20
  v_and_b32 v7, 0xffff0000, v20
  v_lshlrev_b32 v10, 16, v21
  v_and_b32 v11, 0xffff0000, v21
  v_mul_f32 v22, v6, v6
  v_fma_f32 v22, v22, s30, 1.0
  v_mul_f32 v22, v22, v6
  v_mul_f32 v22, s31, v22
  v_exp_f32 v22, v22
  v_mul_f32 v23, v7, v7
  v_fma_f32 v23, v23, s30, 1.0
  v_mul_f32 v23, v23, v7
  v_mul_f32 v23, s31, v23
  v_exp_f32 v23, v23
  v_add_f32 v22, 1.0, v22
  v_rcp_f32 v22, v22
  v_add_f32 v23, 1.0, v23
  v_rcp_f32 v23, v23
  v_mul_f32 v22, v22, v6
  v_mul_f32 v23, v23, v7
  v_cvt_pk_bf16_f32 v20, v22, v23
  v_lshlrev_b32 v22, 16, v20
  v_and_b32 v23, 0xffff0000, v20
  v_mul_f32 v22, v22, v10
  v_mul_f32 v23, v23, v11
  v_cvt_pk_bf16_f32 v13, v22, v23
  buffer_store_dwordx2 v[12:13], v92, s[20:23], s25 offen offset:2048 sc1
  v_accvgpr_read_b32 v4, a40
  v_accvgpr_read_b32 v8, a96
  v_accvgpr_read_b32 v5, a41
  v_accvgpr_read_b32 v9, a97
  v_accvgpr_read_b32 v6, a42
  v_accvgpr_read_b32 v10, a98
  v_accvgpr_read_b32 v7, a43
  v_accvgpr_read_b32 v11, a99
  v_cvt_pk_bf16_f32 v20, v4, v5
  v_cvt_pk_bf16_f32 v21, v8, v9
  v_lshlrev_b32 v4, 16, v20
  v_and_b32 v5, 0xffff0000, v20
  v_lshlrev_b32 v8, 16, v21
  v_and_b32 v9, 0xffff0000, v21
  v_mul_f32 v22, v4, v4
  v_fma_f32 v22, v22, s30, 1.0
  v_mul_f32 v22, v22, v4
  v_mul_f32 v22, s31, v22
  v_exp_f32 v22, v22
  v_mul_f32 v23, v5, v5
  v_fma_f32 v23, v23, s30, 1.0
  v_mul_f32 v23, v23, v5
  v_mul_f32 v23, s31, v23
  v_exp_f32 v23, v23
  v_add_f32 v22, 1.0, v22
  v_rcp_f32 v22, v22
  v_add_f32 v23, 1.0, v23
  v_rcp_f32 v23, v23
  v_mul_f32 v22, v22, v4
  v_mul_f32 v23, v23, v5
  v_cvt_pk_bf16_f32 v20, v22, v23
  v_lshlrev_b32 v22, 16, v20
  v_and_b32 v23, 0xffff0000, v20
  v_mul_f32 v22, v22, v8
  v_mul_f32 v23, v23, v9
  v_cvt_pk_bf16_f32 v14, v22, v23
  v_cvt_pk_bf16_f32 v20, v6, v7
  v_cvt_pk_bf16_f32 v21, v10, v11
  v_lshlrev_b32 v6, 16, v20
  v_and_b32 v7, 0xffff0000, v20
  v_lshlrev_b32 v10, 16, v21
  v_and_b32 v11, 0xffff0000, v21
  v_mul_f32 v22, v6, v6
  v_fma_f32 v22, v22, s30, 1.0
  v_mul_f32 v22, v22, v6
  v_mul_f32 v22, s31, v22
  v_exp_f32 v22, v22
  v_mul_f32 v23, v7, v7
  v_fma_f32 v23, v23, s30, 1.0
  v_mul_f32 v23, v23, v7
  v_mul_f32 v23, s31, v23
  v_exp_f32 v23, v23
  v_add_f32 v22, 1.0, v22
  v_rcp_f32 v22, v22
  v_add_f32 v23, 1.0, v23
  v_rcp_f32 v23, v23
  v_mul_f32 v22, v22, v6
  v_mul_f32 v23, v23, v7
  v_cvt_pk_bf16_f32 v20, v22, v23
  v_lshlrev_b32 v22, 16, v20
  v_and_b32 v23, 0xffff0000, v20
  v_mul_f32 v22, v22, v10
  v_mul_f32 v23, v23, v11
  v_cvt_pk_bf16_f32 v15, v22, v23
  buffer_store_dwordx2 v[14:15], v92, s[20:23], s25 offen offset:2560 sc1
  v_accvgpr_read_b32 v4, a48
  v_accvgpr_read_b32 v8, a104
  v_accvgpr_read_b32 v5, a49
  v_accvgpr_read_b32 v9, a105
  v_accvgpr_read_b32 v6, a50
  v_accvgpr_read_b32 v10, a106
  v_accvgpr_read_b32 v7, a51
  v_accvgpr_read_b32 v11, a107
  v_cvt_pk_bf16_f32 v20, v4, v5
  v_cvt_pk_bf16_f32 v21, v8, v9
  v_lshlrev_b32 v4, 16, v20
  v_and_b32 v5, 0xffff0000, v20
  v_lshlrev_b32 v8, 16, v21
  v_and_b32 v9, 0xffff0000, v21
  v_mul_f32 v22, v4, v4
  v_fma_f32 v22, v22, s30, 1.0
  v_mul_f32 v22, v22, v4
  v_mul_f32 v22, s31, v22
  v_exp_f32 v22, v22
  v_mul_f32 v23, v5, v5
  v_fma_f32 v23, v23, s30, 1.0
  v_mul_f32 v23, v23, v5
  v_mul_f32 v23, s31, v23
  v_exp_f32 v23, v23
  v_add_f32 v22, 1.0, v22
  v_rcp_f32 v22, v22
  v_add_f32 v23, 1.0, v23
  v_rcp_f32 v23, v23
  v_mul_f32 v22, v22, v4
  v_mul_f32 v23, v23, v5
  v_cvt_pk_bf16_f32 v20, v22, v23
  v_lshlrev_b32 v22, 16, v20
  v_and_b32 v23, 0xffff0000, v20
  v_mul_f32 v22, v22, v8
  v_mul_f32 v23, v23, v9
  v_cvt_pk_bf16_f32 v12, v22, v23
  v_cvt_pk_bf16_f32 v20, v6, v7
  v_cvt_pk_bf16_f32 v21, v10, v11
  v_lshlrev_b32 v6, 16, v20
  v_and_b32 v7, 0xffff0000, v20
  v_lshlrev_b32 v10, 16, v21
  v_and_b32 v11, 0xffff0000, v21
  v_mul_f32 v22, v6, v6
  v_fma_f32 v22, v22, s30, 1.0
  v_mul_f32 v22, v22, v6
  v_mul_f32 v22, s31, v22
  v_exp_f32 v22, v22
  v_mul_f32 v23, v7, v7
  v_fma_f32 v23, v23, s30, 1.0
  v_mul_f32 v23, v23, v7
  v_mul_f32 v23, s31, v23
  v_exp_f32 v23, v23
  v_add_f32 v22, 1.0, v22
  v_rcp_f32 v22, v22
  v_add_f32 v23, 1.0, v23
  v_rcp_f32 v23, v23
  v_mul_f32 v22, v22, v6
  v_mul_f32 v23, v23, v7
  v_cvt_pk_bf16_f32 v20, v22, v23
  v_lshlrev_b32 v22, 16, v20
  v_and_b32 v23, 0xffff0000, v20
  v_mul_f32 v22, v22, v10
  v_mul_f32 v23, v23, v11
  v_cvt_pk_bf16_f32 v13, v22, v23
  buffer_store_dwordx2 v[12:13], v92, s[20:23], s25 offen offset:3072 sc1
  s_add_u32 s25, s25, 114688
  v_accvgpr_read_b32 v4, a4
  v_accvgpr_read_b32 v8, a60
  v_accvgpr_read_b32 v5, a5
  v_accvgpr_read_b32 v9, a61
  v_accvgpr_read_b32 v6, a6
  v_accvgpr_read_b32 v10, a62
  v_accvgpr_read_b32 v7, a7
  v_accvgpr_read_b32 v11, a63
  v_cvt_pk_bf16_f32 v20, v4, v5
  v_cvt_pk_bf16_f32 v21, v8, v9
  v_lshlrev_b32 v4, 16, v20
  v_and_b32 v5, 0xffff0000, v20
  v_lshlrev_b32 v8, 16, v21
  v_and_b32 v9, 0xffff0000, v21
  v_mul_f32 v22, v4, v4
  v_fma_f32 v22, v22, s30, 1.0
  v_mul_f32 v22, v22, v4
  v_mul_f32 v22, s31, v22
  v_exp_f32 v22, v22
  v_mul_f32 v23, v5, v5
  v_fma_f32 v23, v23, s30, 1.0
  v_mul_f32 v23, v23, v5
  v_mul_f32 v23, s31, v23
  v_exp_f32 v23, v23
  v_add_f32 v22, 1.0, v22
  v_rcp_f32 v22, v22
  v_add_f32 v23, 1.0, v23
  v_rcp_f32 v23, v23
  v_mul_f32 v22, v22, v4
  v_mul_f32 v23, v23, v5
  v_cvt_pk_bf16_f32 v20, v22, v23
  v_lshlrev_b32 v22, 16, v20
  v_and_b32 v23, 0xffff0000, v20
  v_mul_f32 v22, v22, v8
  v_mul_f32 v23, v23, v9
  v_cvt_pk_bf16_f32 v12, v22, v23
  v_cvt_pk_bf16_f32 v20, v6, v7
  v_cvt_pk_bf16_f32 v21, v10, v11
  v_lshlrev_b32 v6, 16, v20
  v_and_b32 v7, 0xffff0000, v20
  v_lshlrev_b32 v10, 16, v21
  v_and_b32 v11, 0xffff0000, v21
  v_mul_f32 v22, v6, v6
  v_fma_f32 v22, v22, s30, 1.0
  v_mul_f32 v22, v22, v6
  v_mul_f32 v22, s31, v22
  v_exp_f32 v22, v22
  v_mul_f32 v23, v7, v7
  v_fma_f32 v23, v23, s30, 1.0
  v_mul_f32 v23, v23, v7
  v_mul_f32 v23, s31, v23
  v_exp_f32 v23, v23
  v_add_f32 v22, 1.0, v22
  v_rcp_f32 v22, v22
  v_add_f32 v23, 1.0, v23
  v_rcp_f32 v23, v23
  v_mul_f32 v22, v22, v6
  v_mul_f32 v23, v23, v7
  v_cvt_pk_bf16_f32 v20, v22, v23
  v_lshlrev_b32 v22, 16, v20
  v_and_b32 v23, 0xffff0000, v20
  v_mul_f32 v22, v22, v10
  v_mul_f32 v23, v23, v11
  v_cvt_pk_bf16_f32 v13, v22, v23
  buffer_store_dwordx2 v[12:13], v92, s[20:23], s25 offen offset:0 sc1
  v_accvgpr_read_b32 v4, a12
  v_accvgpr_read_b32 v8, a68
  v_accvgpr_read_b32 v5, a13
  v_accvgpr_read_b32 v9, a69
  v_accvgpr_read_b32 v6, a14
  v_accvgpr_read_b32 v10, a70
  v_accvgpr_read_b32 v7, a15
  v_accvgpr_read_b32 v11, a71
  v_cvt_pk_bf16_f32 v20, v4, v5
  v_cvt_pk_bf16_f32 v21, v8, v9
  v_lshlrev_b32 v4, 16, v20
  v_and_b32 v5, 0xffff0000, v20
  v_lshlrev_b32 v8, 16, v21
  v_and_b32 v9, 0xffff0000, v21
  v_mul_f32 v22, v4, v4
  v_fma_f32 v22, v22, s30, 1.0
  v_mul_f32 v22, v22, v4
  v_mul_f32 v22, s31, v22
  v_exp_f32 v22, v22
  v_mul_f32 v23, v5, v5
  v_fma_f32 v23, v23, s30, 1.0
  v_mul_f32 v23, v23, v5
  v_mul_f32 v23, s31, v23
  v_exp_f32 v23, v23
  v_add_f32 v22, 1.0, v22
  v_rcp_f32 v22, v22
  v_add_f32 v23, 1.0, v23
  v_rcp_f32 v23, v23
  v_mul_f32 v22, v22, v4
  v_mul_f32 v23, v23, v5
  v_cvt_pk_bf16_f32 v20, v22, v23
  v_lshlrev_b32 v22, 16, v20
  v_and_b32 v23, 0xffff0000, v20
  v_mul_f32 v22, v22, v8
  v_mul_f32 v23, v23, v9
  v_cvt_pk_bf16_f32 v14, v22, v23
  v_cvt_pk_bf16_f32 v20, v6, v7
  v_cvt_pk_bf16_f32 v21, v10, v11
  v_lshlrev_b32 v6, 16, v20
  v_and_b32 v7, 0xffff0000, v20
  v_lshlrev_b32 v10, 16, v21
  v_and_b32 v11, 0xffff0000, v21
  v_mul_f32 v22, v6, v6
  v_fma_f32 v22, v22, s30, 1.0
  v_mul_f32 v22, v22, v6
  v_mul_f32 v22, s31, v22
  v_exp_f32 v22, v22
  v_mul_f32 v23, v7, v7
  v_fma_f32 v23, v23, s30, 1.0
  v_mul_f32 v23, v23, v7
  v_mul_f32 v23, s31, v23
  v_exp_f32 v23, v23
  v_add_f32 v22, 1.0, v22
  v_rcp_f32 v22, v22
  v_add_f32 v23, 1.0, v23
  v_rcp_f32 v23, v23
  v_mul_f32 v22, v22, v6
  v_mul_f32 v23, v23, v7
  v_cvt_pk_bf16_f32 v20, v22, v23
  v_lshlrev_b32 v22, 16, v20
  v_and_b32 v23, 0xffff0000, v20
  v_mul_f32 v22, v22, v10
  v_mul_f32 v23, v23, v11
  v_cvt_pk_bf16_f32 v15, v22, v23
  buffer_store_dwordx2 v[14:15], v92, s[20:23], s25 offen offset:512 sc1
  v_accvgpr_read_b32 v4, a20
  v_accvgpr_read_b32 v8, a76
  v_accvgpr_read_b32 v5, a21
  v_accvgpr_read_b32 v9, a77
  v_accvgpr_read_b32 v6, a22
  v_accvgpr_read_b32 v10, a78
  v_accvgpr_read_b32 v7, a23
  v_accvgpr_read_b32 v11, a79
  v_cvt_pk_bf16_f32 v20, v4, v5
  v_cvt_pk_bf16_f32 v21, v8, v9
  v_lshlrev_b32 v4, 16, v20
  v_and_b32 v5, 0xffff0000, v20
  v_lshlrev_b32 v8, 16, v21
  v_and_b32 v9, 0xffff0000, v21
  v_mul_f32 v22, v4, v4
  v_fma_f32 v22, v22, s30, 1.0
  v_mul_f32 v22, v22, v4
  v_mul_f32 v22, s31, v22
  v_exp_f32 v22, v22
  v_mul_f32 v23, v5, v5
  v_fma_f32 v23, v23, s30, 1.0
  v_mul_f32 v23, v23, v5
  v_mul_f32 v23, s31, v23
  v_exp_f32 v23, v23
  v_add_f32 v22, 1.0, v22
  v_rcp_f32 v22, v22
  v_add_f32 v23, 1.0, v23
  v_rcp_f32 v23, v23
  v_mul_f32 v22, v22, v4
  v_mul_f32 v23, v23, v5
  v_cvt_pk_bf16_f32 v20, v22, v23
  v_lshlrev_b32 v22, 16, v20
  v_and_b32 v23, 0xffff0000, v20
  v_mul_f32 v22, v22, v8
  v_mul_f32 v23, v23, v9
  v_cvt_pk_bf16_f32 v12, v22, v23
  v_cvt_pk_bf16_f32 v20, v6, v7
  v_cvt_pk_bf16_f32 v21, v10, v11
  v_lshlrev_b32 v6, 16, v20
  v_and_b32 v7, 0xffff0000, v20
  v_lshlrev_b32 v10, 16, v21
  v_and_b32 v11, 0xffff0000, v21
  v_mul_f32 v22, v6, v6
  v_fma_f32 v22, v22, s30, 1.0
  v_mul_f32 v22, v22, v6
  v_mul_f32 v22, s31, v22
  v_exp_f32 v22, v22
  v_mul_f32 v23, v7, v7
  v_fma_f32 v23, v23, s30, 1.0
  v_mul_f32 v23, v23, v7
  v_mul_f32 v23, s31, v23
  v_exp_f32 v23, v23
  v_add_f32 v22, 1.0, v22
  v_rcp_f32 v22, v22
  v_add_f32 v23, 1.0, v23
  v_rcp_f32 v23, v23
  v_mul_f32 v22, v22, v6
  v_mul_f32 v23, v23, v7
  v_cvt_pk_bf16_f32 v20, v22, v23
  v_lshlrev_b32 v22, 16, v20
  v_and_b32 v23, 0xffff0000, v20
  v_mul_f32 v22, v22, v10
  v_mul_f32 v23, v23, v11
  v_cvt_pk_bf16_f32 v13, v22, v23
  buffer_store_dwordx2 v[12:13], v92, s[20:23], s25 offen offset:1024 sc1
  v_accvgpr_read_b32 v4, a28
  v_accvgpr_read_b32 v8, a84
  v_accvgpr_read_b32 v5, a29
  v_accvgpr_read_b32 v9, a85
  v_accvgpr_read_b32 v6, a30
  v_accvgpr_read_b32 v10, a86
  v_accvgpr_read_b32 v7, a31
  v_accvgpr_read_b32 v11, a87
  v_cvt_pk_bf16_f32 v20, v4, v5
  v_cvt_pk_bf16_f32 v21, v8, v9
  v_lshlrev_b32 v4, 16, v20
  v_and_b32 v5, 0xffff0000, v20
  v_lshlrev_b32 v8, 16, v21
  v_and_b32 v9, 0xffff0000, v21
  v_mul_f32 v22, v4, v4
  v_fma_f32 v22, v22, s30, 1.0
  v_mul_f32 v22, v22, v4
  v_mul_f32 v22, s31, v22
  v_exp_f32 v22, v22
  v_mul_f32 v23, v5, v5
  v_fma_f32 v23, v23, s30, 1.0
  v_mul_f32 v23, v23, v5
  v_mul_f32 v23, s31, v23
  v_exp_f32 v23, v23
  v_add_f32 v22, 1.0, v22
  v_rcp_f32 v22, v22
  v_add_f32 v23, 1.0, v23
  v_rcp_f32 v23, v23
  v_mul_f32 v22, v22, v4
  v_mul_f32 v23, v23, v5
  v_cvt_pk_bf16_f32 v20, v22, v23
  v_lshlrev_b32 v22, 16, v20
  v_and_b32 v23, 0xffff0000, v20
  v_mul_f32 v22, v22, v8
  v_mul_f32 v23, v23, v9
  v_cvt_pk_bf16_f32 v14, v22, v23
  v_cvt_pk_bf16_f32 v20, v6, v7
  v_cvt_pk_bf16_f32 v21, v10, v11
  v_lshlrev_b32 v6, 16, v20
  v_and_b32 v7, 0xffff0000, v20
  v_lshlrev_b32 v10, 16, v21
  v_and_b32 v11, 0xffff0000, v21
  v_mul_f32 v22, v6, v6
  v_fma_f32 v22, v22, s30, 1.0
  v_mul_f32 v22, v22, v6
  v_mul_f32 v22, s31, v22
  v_exp_f32 v22, v22
  v_mul_f32 v23, v7, v7
  v_fma_f32 v23, v23, s30, 1.0
  v_mul_f32 v23, v23, v7
  v_mul_f32 v23, s31, v23
  v_exp_f32 v23, v23
  v_add_f32 v22, 1.0, v22
  v_rcp_f32 v22, v22
  v_add_f32 v23, 1.0, v23
  v_rcp_f32 v23, v23
  v_mul_f32 v22, v22, v6
  v_mul_f32 v23, v23, v7
  v_cvt_pk_bf16_f32 v20, v22, v23
  v_lshlrev_b32 v22, 16, v20
  v_and_b32 v23, 0xffff0000, v20
  v_mul_f32 v22, v22, v10
  v_mul_f32 v23, v23, v11
  v_cvt_pk_bf16_f32 v15, v22, v23
  buffer_store_dwordx2 v[14:15], v92, s[20:23], s25 offen offset:1536 sc1
  v_accvgpr_read_b32 v4, a36
  v_accvgpr_read_b32 v8, a92
  v_accvgpr_read_b32 v5, a37
  v_accvgpr_read_b32 v9, a93
  v_accvgpr_read_b32 v6, a38
  v_accvgpr_read_b32 v10, a94
  v_accvgpr_read_b32 v7, a39
  v_accvgpr_read_b32 v11, a95
  v_cvt_pk_bf16_f32 v20, v4, v5
  v_cvt_pk_bf16_f32 v21, v8, v9
  v_lshlrev_b32 v4, 16, v20
  v_and_b32 v5, 0xffff0000, v20
  v_lshlrev_b32 v8, 16, v21
  v_and_b32 v9, 0xffff0000, v21
  v_mul_f32 v22, v4, v4
  v_fma_f32 v22, v22, s30, 1.0
  v_mul_f32 v22, v22, v4
  v_mul_f32 v22, s31, v22
  v_exp_f32 v22, v22
  v_mul_f32 v23, v5, v5
  v_fma_f32 v23, v23, s30, 1.0
  v_mul_f32 v23, v23, v5
  v_mul_f32 v23, s31, v23
  v_exp_f32 v23, v23
  v_add_f32 v22, 1.0, v22
  v_rcp_f32 v22, v22
  v_add_f32 v23, 1.0, v23
  v_rcp_f32 v23, v23
  v_mul_f32 v22, v22, v4
  v_mul_f32 v23, v23, v5
  v_cvt_pk_bf16_f32 v20, v22, v23
  v_lshlrev_b32 v22, 16, v20
  v_and_b32 v23, 0xffff0000, v20
  v_mul_f32 v22, v22, v8
  v_mul_f32 v23, v23, v9
  v_cvt_pk_bf16_f32 v12, v22, v23
  v_cvt_pk_bf16_f32 v20, v6, v7
  v_cvt_pk_bf16_f32 v21, v10, v11
  v_lshlrev_b32 v6, 16, v20
  v_and_b32 v7, 0xffff0000, v20
  v_lshlrev_b32 v10, 16, v21
  v_and_b32 v11, 0xffff0000, v21
  v_mul_f32 v22, v6, v6
  v_fma_f32 v22, v22, s30, 1.0
  v_mul_f32 v22, v22, v6
  v_mul_f32 v22, s31, v22
  v_exp_f32 v22, v22
  v_mul_f32 v23, v7, v7
  v_fma_f32 v23, v23, s30, 1.0
  v_mul_f32 v23, v23, v7
  v_mul_f32 v23, s31, v23
  v_exp_f32 v23, v23
  v_add_f32 v22, 1.0, v22
  v_rcp_f32 v22, v22
  v_add_f32 v23, 1.0, v23
  v_rcp_f32 v23, v23
  v_mul_f32 v22, v22, v6
  v_mul_f32 v23, v23, v7
  v_cvt_pk_bf16_f32 v20, v22, v23
  v_lshlrev_b32 v22, 16, v20
  v_and_b32 v23, 0xffff0000, v20
  v_mul_f32 v22, v22, v10
  v_mul_f32 v23, v23, v11
  v_cvt_pk_bf16_f32 v13, v22, v23
  buffer_store_dwordx2 v[12:13], v92, s[20:23], s25 offen offset:2048 sc1
  v_accvgpr_read_b32 v4, a44
  v_accvgpr_read_b32 v8, a100
  v_accvgpr_read_b32 v5, a45
  v_accvgpr_read_b32 v9, a101
  v_accvgpr_read_b32 v6, a46
  v_accvgpr_read_b32 v10, a102
  v_accvgpr_read_b32 v7, a47
  v_accvgpr_read_b32 v11, a103
  v_cvt_pk_bf16_f32 v20, v4, v5
  v_cvt_pk_bf16_f32 v21, v8, v9
  v_lshlrev_b32 v4, 16, v20
  v_and_b32 v5, 0xffff0000, v20
  v_lshlrev_b32 v8, 16, v21
  v_and_b32 v9, 0xffff0000, v21
  v_mul_f32 v22, v4, v4
  v_fma_f32 v22, v22, s30, 1.0
  v_mul_f32 v22, v22, v4
  v_mul_f32 v22, s31, v22
  v_exp_f32 v22, v22
  v_mul_f32 v23, v5, v5
  v_fma_f32 v23, v23, s30, 1.0
  v_mul_f32 v23, v23, v5
  v_mul_f32 v23, s31, v23
  v_exp_f32 v23, v23
  v_add_f32 v22, 1.0, v22
  v_rcp_f32 v22, v22
  v_add_f32 v23, 1.0, v23
  v_rcp_f32 v23, v23
  v_mul_f32 v22, v22, v4
  v_mul_f32 v23, v23, v5
  v_cvt_pk_bf16_f32 v20, v22, v23
  v_lshlrev_b32 v22, 16, v20
  v_and_b32 v23, 0xffff0000, v20
  v_mul_f32 v22, v22, v8
  v_mul_f32 v23, v23, v9
  v_cvt_pk_bf16_f32 v14, v22, v23
  v_cvt_pk_bf16_f32 v20, v6, v7
  v_cvt_pk_bf16_f32 v21, v10, v11
  v_lshlrev_b32 v6, 16, v20
  v_and_b32 v7, 0xffff0000, v20
  v_lshlrev_b32 v10, 16, v21
  v_and_b32 v11, 0xffff0000, v21
  v_mul_f32 v22, v6, v6
  v_fma_f32 v22, v22, s30, 1.0
  v_mul_f32 v22, v22, v6
  v_mul_f32 v22, s31, v22
  v_exp_f32 v22, v22
  v_mul_f32 v23, v7, v7
  v_fma_f32 v23, v23, s30, 1.0
  v_mul_f32 v23, v23, v7
  v_mul_f32 v23, s31, v23
  v_exp_f32 v23, v23
  v_add_f32 v22, 1.0, v22
  v_rcp_f32 v22, v22
  v_add_f32 v23, 1.0, v23
  v_rcp_f32 v23, v23
  v_mul_f32 v22, v22, v6
  v_mul_f32 v23, v23, v7
  v_cvt_pk_bf16_f32 v20, v22, v23
  v_lshlrev_b32 v22, 16, v20
  v_and_b32 v23, 0xffff0000, v20
  v_mul_f32 v22, v22, v10
  v_mul_f32 v23, v23, v11
  v_cvt_pk_bf16_f32 v15, v22, v23
  buffer_store_dwordx2 v[14:15], v92, s[20:23], s25 offen offset:2560 sc1
  v_accvgpr_read_b32 v4, a52
  v_accvgpr_read_b32 v8, a108
  v_accvgpr_read_b32 v5, a53
  v_accvgpr_read_b32 v9, a109
  v_accvgpr_read_b32 v6, a54
  v_accvgpr_read_b32 v10, a110
  v_accvgpr_read_b32 v7, a55
  v_accvgpr_read_b32 v11, a111
  v_cvt_pk_bf16_f32 v20, v4, v5
  v_cvt_pk_bf16_f32 v21, v8, v9
  v_lshlrev_b32 v4, 16, v20
  v_and_b32 v5, 0xffff0000, v20
  v_lshlrev_b32 v8, 16, v21
  v_and_b32 v9, 0xffff0000, v21
  v_mul_f32 v22, v4, v4
  v_fma_f32 v22, v22, s30, 1.0
  v_mul_f32 v22, v22, v4
  v_mul_f32 v22, s31, v22
  v_exp_f32 v22, v22
  v_mul_f32 v23, v5, v5
  v_fma_f32 v23, v23, s30, 1.0
  v_mul_f32 v23, v23, v5
  v_mul_f32 v23, s31, v23
  v_exp_f32 v23, v23
  v_add_f32 v22, 1.0, v22
  v_rcp_f32 v22, v22
  v_add_f32 v23, 1.0, v23
  v_rcp_f32 v23, v23
  v_mul_f32 v22, v22, v4
  v_mul_f32 v23, v23, v5
  v_cvt_pk_bf16_f32 v20, v22, v23
  v_lshlrev_b32 v22, 16, v20
  v_and_b32 v23, 0xffff0000, v20
  v_mul_f32 v22, v22, v8
  v_mul_f32 v23, v23, v9
  v_cvt_pk_bf16_f32 v12, v22, v23
  v_cvt_pk_bf16_f32 v20, v6, v7
  v_cvt_pk_bf16_f32 v21, v10, v11
  v_lshlrev_b32 v6, 16, v20
  v_and_b32 v7, 0xffff0000, v20
  v_lshlrev_b32 v10, 16, v21
  v_and_b32 v11, 0xffff0000, v21
  v_mul_f32 v22, v6, v6
  v_fma_f32 v22, v22, s30, 1.0
  v_mul_f32 v22, v22, v6
  v_mul_f32 v22, s31, v22
  v_exp_f32 v22, v22
  v_mul_f32 v23, v7, v7
  v_fma_f32 v23, v23, s30, 1.0
  v_mul_f32 v23, v23, v7
  v_mul_f32 v23, s31, v23
  v_exp_f32 v23, v23
  v_add_f32 v22, 1.0, v22
  v_rcp_f32 v22, v22
  v_add_f32 v23, 1.0, v23
  v_rcp_f32 v23, v23
  v_mul_f32 v22, v22, v6
  v_mul_f32 v23, v23, v7
  v_cvt_pk_bf16_f32 v20, v22, v23
  v_lshlrev_b32 v22, 16, v20
  v_and_b32 v23, 0xffff0000, v20
  v_mul_f32 v22, v22, v10
  v_mul_f32 v23, v23, v11
  v_cvt_pk_bf16_f32 v13, v22, v23
  buffer_store_dwordx2 v[12:13], v92, s[20:23], s25 offen offset:3072 sc1
  s_add_u32 s25, s25, 114688
G1_done:
  s_endpgm
.globl ffn2_kernel
.p2align 8
.type ffn2_kernel,@function
ffn2_kernel:
  s_cmp_ge_u32 s2, 256
  s_cbranch_scc1 G2_done
  s_load_dwordx4 s[4:7], s[0:1], 48
  s_load_dwordx2 s[10:11], s[0:1], 72
  v_and_b32 v1, 63, v0
  v_lshrrev_b32 v5, 6, v0
  s_nop 0
  v_readfirstlane_b32 s24, v5
  v_and_b32 v2, 15, v1
  v_lshrrev_b32 v3, 4, v1
  s_waitcnt lgkmcnt(0)
  s_mov_b32 s12, s4
  s_and_b32 s13, s5, 0xffff
  s_mov_b32 s14, 0x700000
  s_mov_b32 s15, 0x00020000
  s_mov_b32 s16, s6
  s_and_b32 s17, s7, 0xffff
  s_mov_b32 s18, 0x400000
  s_mov_b32 s19, 0x00020000
  s_mov_b32 s20, s10
  s_and_b32 s21, s11, 0xffff
  s_mov_b32 s22, 0x10000000
  s_mov_b32 s23, 0x00020000
  s_and_b32 s3, s2, 7
  s_lshr_b32 s8, s2, 3
  s_lshr_b32 s9, s3, 1
  s_lshl_b32 s9, s9, 2
  s_and_b32 s27, s8, 3
  s_add_u32 s9, s9, s27
  s_and_b32 s3, s3, 1
  s_lshl_b32 s3, s3, 3
  s_lshr_b32 s8, s8, 2
  s_add_u32 s3, s3, s8
  s_lshl_b32 s29, s9, 7
  s_lshl_b32 s30, s3, 6
  s_mul_i32 s27, s24, 896
  s_mul_i32 s26, s29, 7168
  s_lshl_b32 s28, s27, 5
  s_add_u32 s26, s26, s28
  s_add_u32 s26, s26, 0x1800000
  s_lshl_b32 s25, s27, 11
  v_lshlrev_b32 v6, 4, v1
  v_add_u32 v7, 0x1c000, v6
  v_add_u32 v8, 0x38000, v6
  v_add_u32 v9, 0x54000, v6
  v_add_u32 v10, 0x70000, v6
  v_add_u32 v11, 0x8c000, v6
  v_add_u32 v12, 0xa8000, v6
  v_add_u32 v13, 0xc4000, v6
  v_lshrrev_b32 v18, 3, v1
  v_and_b32 v19, 7, v1
  v_lshrrev_b32 v20, 1, v19
  v_and_b32 v19, 1, v19
  v_bfe_u32 v21, v18, 1, 1
  v_or_b32 v22, 0, v21
  v_xor_b32 v22, v22, v20
  v_lshlrev_b32 v22, 4, v22
  v_lshl_add_u32 v22, v19, 3, v22
  v_add_u32 v22, s30, v22
  v_lshlrev_b32 v22, 1, v22
  v_add_u32 v23, 0, v18
  v_lshl_add_u32 v14, v23, 11, v22
  v_or_b32 v22, 2, v21
  v_xor_b32 v22, v22, v20
  v_lshlrev_b32 v22, 4, v22
  v_lshl_add_u32 v22, v19, 3, v22
  v_add_u32 v22, s30, v22
  v_lshlrev_b32 v22, 1, v22
  v_add_u32 v23, 8, v18
  v_lshl_add_u32 v15, v23, 11, v22
  v_or_b32 v22, 0, v21
  v_xor_b32 v22, v22, v20
  v_lshlrev_b32 v22, 4, v22
  v_lshl_add_u32 v22, v19, 3, v22
  v_add_u32 v22, s30, v22
  v_lshlrev_b32 v22, 1, v22
  v_add_u32 v23, 16, v18
  v_lshl_add_u32 v16, v23, 11, v22
  v_or_b32 v22, 2, v21
  v_xor_b32 v22, v22, v20
  v_lshlrev_b32 v22, 4, v22
  v_lshl_add_u32 v22, v19, 3, v22
  v_add_u32 v22, s30, v22
  v_lshlrev_b32 v22, 1, v22
  v_add_u32 v23, 24, v18
  v_lshl_add_u32 v17, v23, 11, v22
  s_lshl_b32 s28, s24, 14
  v_lshrrev_b32 v18, 2, v1
  v_and_b32 v18, 3, v18
  v_lshrrev_b32 v19, 1, v18
  v_and_b32 v20, 1, v3
  v_lshl_or_b32 v19, v20, 1, v19
  v_lshl_add_u32 v20, v3, 3, v18
  v_lshlrev_b32 v20, 7, v20
  v_and_b32 v21, 3, v1
  v_lshl_add_u32 v20, v21, 3, v20
  v_add_u32 v20, s28, v20
  v_xor_b32 v21, 0, v19
  v_lshl_add_u32 v26, v21, 5, v20
  v_xor_b32 v21, 1, v19
  v_lshl_add_u32 v27, v21, 5, v20
  v_xor_b32 v21, 2, v19
  v_lshl_add_u32 v28, v21, 5, v20
  v_xor_b32 v21, 3, v19
  v_lshl_add_u32 v29, v21, 5, v20
  s_add_u32 m0, s28, 0
  s_nop 0
  buffer_load_dwordx4 v14, s[12:15], s25 offen lds
  s_add_u32 m0, s28, 1024
  s_nop 0
  buffer_load_dwordx4 v15, s[12:15], s25 offen lds
  s_add_u32 m0, s28, 2048
  s_nop 0
  buffer_load_dwordx4 v16, s[12:15], s25 offen lds
  s_add_u32 m0, s28, 3072
  s_nop 0
  buffer_load_dwordx4 v17, s[12:15], s25 offen lds
  buffer_load_dwordx4 v[32:35], v6, s[20:23], s26 offen
  buffer_load_dwordx4 v[36:39], v7, s[20:23], s26 offen
  buffer_load_dwordx4 v[40:43], v8, s[20:23], s26 offen
  buffer_load_dwordx4 v[44:47], v9, s[20:23], s26 offen
  buffer_load_dwordx4 v[48:51], v10, s[20:23], s26 offen
  buffer_load_dwordx4 v[52:55], v11, s[20:23], s26 offen
  buffer_load_dwordx4 v[56:59], v12, s[20:23], s26 offen
  buffer_load_dwordx4 v[60:63], v13, s[20:23], s26 offen
  s_add_u32 s25, s25, 65536
  s_add_u32 s26, s26, 1024
  s_add_u32 m0, s28, 4096
  s_nop 0
  buffer_load_dwordx4 v14, s[12:15], s25 offen lds
  s_add_u32 m0, s28, 5120
  s_nop 0
  buffer_load_dwordx4 v15, s[12:15], s25 offen lds
  s_add_u32 m0, s28, 6144
  s_nop 0
  buffer_load_dwordx4 v16, s[12:15], s25 offen lds
  s_add_u32 m0, s28, 7168
  s_nop 0
  buffer_load_dwordx4 v17, s[12:15], s25 offen lds
  buffer_load_dwordx4 v[64:67], v6, s[20:23], s26 offen
  buffer_load_dwordx4 v[68:71], v7, s[20:23], s26 offen
  buffer_load_dwordx4 v[72:75], v8, s[20:23], s26 offen
  buffer_load_dwordx4 v[76:79], v9, s[20:23], s26 offen
  buffer_load_dwordx4 v[80:83], v10, s[20:23], s26 offen
  buffer_load_dwordx4 v[84:87], v11, s[20:23], s26 offen
  buffer_load_dwordx4 v[88:91], v12, s[20:23], s26 offen
  buffer_load_dwordx4 v[92:95], v13, s[20:23], s26 offen
  s_add_u32 s25, s25, 65536
  s_add_u32 s26, s26, 1024
  s_add_u32 m0, s28, 8192
  s_nop 0
  buffer_load_dwordx4 v14, s[12:15], s25 offen lds
  s_add_u32 m0, s28, 9216
  s_nop 0
  buffer_load_dwordx4 v15, s[12:15], s25 offen lds
  s_add_u32 m0, s28, 10240
  s_nop 0
  buffer_load_dwordx4 v16, s[12:15], s25 offen lds
  s_add_u32 m0, s28, 11264
  s_nop 0
  buffer_load_dwordx4 v17, s[12:15], s25 offen lds
  buffer_load_dwordx4 v[96:99], v6, s[20:23], s26 offen
  buffer_load_dwordx4 v[100:103], v7, s[20:23], s26 offen
  buffer_load_dwordx4 v[104:107], v8, s[20:23], s26 offen
  buffer_load_dwordx4 v[108:111], v9, s[20:23], s26 offen
  buffer_load_dwordx4 v[112:115], v10, s[20:23], s26 offen
  buffer_load_dwordx4 v[116:119], v11, s[20:23], s26 offen
  buffer_load_dwordx4 v[120:123], v12, s[20:23], s26 offen
  buffer_load_dwordx4 v[124:127], v13, s[20:23], s26 offen
  s_add_u32 s25, s25, 65536
  s_add_u32 s26, s26, 1024
  v_accvgpr_write_b32 a0, 0
  v_accvgpr_write_b32 a1, 0
  v_accvgpr_write_b32 a2, 0
  v_accvgpr_write_b32 a3, 0
  v_accvgpr_write_b32 a4, 0
  v_accvgpr_write_b32 a5, 0
  v_accvgpr_write_b32 a6, 0
  v_accvgpr_write_b32 a7, 0
  v_accvgpr_write_b32 a8, 0
  v_accvgpr_write_b32 a9, 0
  v_accvgpr_write_b32 a10, 0
  v_accvgpr_write_b32 a11, 0
  v_accvgpr_write_b32 a12, 0
  v_accvgpr_write_b32 a13, 0
  v_accvgpr_write_b32 a14, 0
  v_accvgpr_write_b32 a15, 0
  v_accvgpr_write_b32 a16, 0
  v_accvgpr_write_b32 a17, 0
  v_accvgpr_write_b32 a18, 0
  v_accvgpr_write_b32 a19, 0
  v_accvgpr_write_b32 a20, 0
  v_accvgpr_write_b32 a21, 0
  v_accvgpr_write_b32 a22, 0
  v_accvgpr_write_b32 a23, 0
  v_accvgpr_write_b32 a24, 0
  v_accvgpr_write_b32 a25, 0
  v_accvgpr_write_b32 a26, 0
  v_accvgpr_write_b32 a27, 0
  v_accvgpr_write_b32 a28, 0
  v_accvgpr_write_b32 a29, 0
  v_accvgpr_write_b32 a30, 0
  v_accvgpr_write_b32 a31, 0
  v_accvgpr_write_b32 a32, 0
  v_accvgpr_write_b32 a33, 0
  v_accvgpr_write_b32 a34, 0
  v_accvgpr_write_b32 a35, 0
  v_accvgpr_write_b32 a36, 0
  v_accvgpr_write_b32 a37, 0
  v_accvgpr_write_b32 a38, 0
  v_accvgpr_write_b32 a39, 0
  v_accvgpr_write_b32 a40, 0
  v_accvgpr_write_b32 a41, 0
  v_accvgpr_write_b32 a42, 0
  v_accvgpr_write_b32 a43, 0
  v_accvgpr_write_b32 a44, 0
  v_accvgpr_write_b32 a45, 0
  v_accvgpr_write_b32 a46, 0
  v_accvgpr_write_b32 a47, 0
  v_accvgpr_write_b32 a48, 0
  v_accvgpr_write_b32 a49, 0
  v_accvgpr_write_b32 a50, 0
  v_accvgpr_write_b32 a51, 0
  v_accvgpr_write_b32 a52, 0
  v_accvgpr_write_b32 a53, 0
  v_accvgpr_write_b32 a54, 0
  v_accvgpr_write_b32 a55, 0
  v_accvgpr_write_b32 a56, 0
  v_accvgpr_write_b32 a57, 0
  v_accvgpr_write_b32 a58, 0
  v_accvgpr_write_b32 a59, 0
  v_accvgpr_write_b32 a60, 0
  v_accvgpr_write_b32 a61, 0
  v_accvgpr_write_b32 a62, 0
  v_accvgpr_write_b32 a63, 0
  v_accvgpr_write_b32 a64, 0
  v_accvgpr_write_b32 a65, 0
  v_accvgpr_write_b32 a66, 0
  v_accvgpr_write_b32 a67, 0
  v_accvgpr_write_b32 a68, 0
  v_accvgpr_write_b32 a69, 0
  v_accvgpr_write_b32 a70, 0
  v_accvgpr_write_b32 a71, 0
  v_accvgpr_write_b32 a72, 0
  v_accvgpr_write_b32 a73, 0
  v_accvgpr_write_b32 a74, 0
  v_accvgpr_write_b32 a75, 0
  v_accvgpr_write_b32 a76, 0
  v_accvgpr_write_b32 a77, 0
  v_accvgpr_write_b32 a78, 0
  v_accvgpr_write_b32 a79, 0
  v_accvgpr_write_b32 a80, 0
  v_accvgpr_write_b32 a81, 0
  v_accvgpr_write_b32 a82, 0
  v_accvgpr_write_b32 a83, 0
  v_accvgpr_write_b32 a84, 0
  v_accvgpr_write_b32 a85, 0
  v_accvgpr_write_b32 a86, 0
  v_accvgpr_write_b32 a87, 0
  v_accvgpr_write_b32 a88, 0
  v_accvgpr_write_b32 a89, 0
  v_accvgpr_write_b32 a90, 0
  v_accvgpr_write_b32 a91, 0
  v_accvgpr_write_b32 a92, 0
  v_accvgpr_write_b32 a93, 0
  v_accvgpr_write_b32 a94, 0
  v_accvgpr_write_b32 a95, 0
  v_accvgpr_write_b32 a96, 0
  v_accvgpr_write_b32 a97, 0
  v_accvgpr_write_b32 a98, 0
  v_accvgpr_write_b32 a99, 0
  v_accvgpr_write_b32 a100, 0
  v_accvgpr_write_b32 a101, 0
  v_accvgpr_write_b32 a102, 0
  v_accvgpr_write_b32 a103, 0
  v_accvgpr_write_b32 a104, 0
  v_accvgpr_write_b32 a105, 0
  v_accvgpr_write_b32 a106, 0
  v_accvgpr_write_b32 a107, 0
  v_accvgpr_write_b32 a108, 0
  v_accvgpr_write_b32 a109, 0
  v_accvgpr_write_b32 a110, 0
  v_accvgpr_write_b32 a111, 0
  v_accvgpr_write_b32 a112, 0
  v_accvgpr_write_b32 a113, 0
  v_accvgpr_write_b32 a114, 0
  v_accvgpr_write_b32 a115, 0
  v_accvgpr_write_b32 a116, 0
  v_accvgpr_write_b32 a117, 0
  v_accvgpr_write_b32 a118, 0
  v_accvgpr_write_b32 a119, 0
  v_accvgpr_write_b32 a120, 0
  v_accvgpr_write_b32 a121, 0
  v_accvgpr_write_b32 a122, 0
  v_accvgpr_write_b32 a123, 0
  v_accvgpr_write_b32 a124, 0
  v_accvgpr_write_b32 a125, 0
  v_accvgpr_write_b32 a126, 0
  v_accvgpr_write_b32 a127, 0
  s_waitcnt vmcnt(32)
  ds_read_b64_tr_b16 v[160:161], v26 offset:0
  ds_read_b64_tr_b16 v[162:163], v26 offset:512
  ds_read_b64_tr_b16 v[164:165], v27 offset:0
  ds_read_b64_tr_b16 v[166:167], v27 offset:512
  ds_read_b64_tr_b16 v[168:169], v28 offset:0
  ds_read_b64_tr_b16 v[170:171], v28 offset:512
  ds_read_b64_tr_b16 v[172:173], v29 offset:0
  ds_read_b64_tr_b16 v[174:175], v29 offset:512
  s_mov_b32 s27, 0
G2_loop:
  s_waitcnt vmcnt(20) lgkmcnt(0)
  v_mfma_f32_16x16x32_bf16 a[0:3], v[160:163], v[32:35], a[0:3]
  v_mfma_f32_16x16x32_bf16 a[32:35], v[164:167], v[32:35], a[32:35]
  ds_read_b64_tr_b16 v[176:177], v26 offset:4096
  v_mfma_f32_16x16x32_bf16 a[64:67], v[168:171], v[32:35], a[64:67]
  s_add_u32 m0, s28, 12288
  s_nop 0
  buffer_load_dwordx4 v14, s[12:15], s25 offen lds
  v_mfma_f32_16x16x32_bf16 a[96:99], v[172:175], v[32:35], a[96:99]
  v_mfma_f32_16x16x32_bf16 a[4:7], v[160:163], v[36:39], a[4:7]
  v_mfma_f32_16x16x32_bf16 a[36:39], v[164:167], v[36:39], a[36:39]
  ds_read_b64_tr_b16 v[178:179], v26 offset:4608
  s_add_u32 m0, s28, 13312
  s_nop 0
  buffer_load_dwordx4 v15, s[12:15], s25 offen lds
  v_mfma_f32_16x16x32_bf16 a[68:71], v[168:171], v[36:39], a[68:71]
  v_mfma_f32_16x16x32_bf16 a[100:103], v[172:175], v[36:39], a[100:103]
  s_add_u32 m0, s28, 14336
  s_nop 0
  buffer_load_dwordx4 v16, s[12:15], s25 offen lds
  v_mfma_f32_16x16x32_bf16 a[8:11], v[160:163], v[40:43], a[8:11]
  v_mfma_f32_16x16x32_bf16 a[40:43], v[164:167], v[40:43], a[40:43]
  ds_read_b64_tr_b16 v[180:181], v27 offset:4096
  v_mfma_f32_16x16x32_bf16 a[72:75], v[168:171], v[40:43], a[72:75]
  s_add_u32 m0, s28, 15360
  s_nop 0
  buffer_load_dwordx4 v17, s[12:15], s25 offen lds
  v_mfma_f32_16x16x32_bf16 a[104:107], v[172:175], v[40:43], a[104:107]
  v_mfma_f32_16x16x32_bf16 a[12:15], v[160:163], v[44:47], a[12:15]
  v_mfma_f32_16x16x32_bf16 a[44:47], v[164:167], v[44:47], a[44:47]
  ds_read_b64_tr_b16 v[182:183], v27 offset:4608
  buffer_load_dwordx4 v[128:131], v6, s[20:23], s26 offen
  v_mfma_f32_16x16x32_bf16 a[76:79], v[168:171], v[44:47], a[76:79]
  v_mfma_f32_16x16x32_bf16 a[108:111], v[172:175], v[44:47], a[108:111]
  buffer_load_dwordx4 v[132:135], v7, s[20:23], s26 offen
  v_mfma_f32_16x16x32_bf16 a[16:19], v[160:163], v[48:51], a[16:19]
  v_mfma_f32_16x16x32_bf16 a[48:51], v[164:167], v[48:51], a[48:51]
  ds_read_b64_tr_b16 v[184:185], v28 offset:4096
  v_mfma_f32_16x16x32_bf16 a[80:83], v[168:171], v[48:51], a[80:83]
  buffer_load_dwordx4 v[136:139], v8, s[20:23], s26 offen
  v_mfma_f32_16x16x32_bf16 a[112:115], v[172:175], v[48:51], a[112:115]
  v_mfma_f32_16x16x32_bf16 a[20:23], v[160:163], v[52:55], a[20:23]
  v_mfma_f32_16x16x32_bf16 a[52:55], v[164:167], v[52:55], a[52:55]
  ds_read_b64_tr_b16 v[186:187], v28 offset:4608
  buffer_load_dwordx4 v[140:143], v9, s[20:23], s26 offen
  v_mfma_f32_16x16x32_bf16 a[84:87], v[168:171], v[52:55], a[84:87]
  v_mfma_f32_16x16x32_bf16 a[116:119], v[172:175], v[52:55], a[116:119]
  buffer_load_dwordx4 v[144:147], v10, s[20:23], s26 offen
  v_mfma_f32_16x16x32_bf16 a[24:27], v[160:163], v[56:59], a[24:27]
  v_mfma_f32_16x16x32_bf16 a[56:59], v[164:167], v[56:59], a[56:59]
  ds_read_b64_tr_b16 v[188:189], v29 offset:4096
  v_mfma_f32_16x16x32_bf16 a[88:91], v[168:171], v[56:59], a[88:91]
  buffer_load_dwordx4 v[148:151], v11, s[20:23], s26 offen
  v_mfma_f32_16x16x32_bf16 a[120:123], v[172:175], v[56:59], a[120:123]
  v_mfma_f32_16x16x32_bf16 a[28:31], v[160:163], v[60:63], a[28:31]
  v_mfma_f32_16x16x32_bf16 a[60:63], v[164:167], v[60:63], a[60:63]
  ds_read_b64_tr_b16 v[190:191], v29 offset:4608
  buffer_load_dwordx4 v[152:155], v12, s[20:23], s26 offen
  v_mfma_f32_16x16x32_bf16 a[92:95], v[168:171], v[60:63], a[92:95]
  v_mfma_f32_16x16x32_bf16 a[124:127], v[172:175], v[60:63], a[124:127]
  buffer_load_dwordx4 v[156:159], v13, s[20:23], s26 offen
  s_add_u32 s25, s25, 65536
  s_add_u32 s26, s26, 1024
  s_waitcnt vmcnt(20) lgkmcnt(0)
  v_mfma_f32_16x16x32_bf16 a[0:3], v[176:179], v[64:67], a[0:3]
  v_mfma_f32_16x16x32_bf16 a[32:35], v[180:183], v[64:67], a[32:35]
  ds_read_b64_tr_b16 v[160:161], v26 offset:8192
  v_mfma_f32_16x16x32_bf16 a[64:67], v[184:187], v[64:67], a[64:67]
  s_add_u32 m0, s28, 0
  s_nop 0
  buffer_load_dwordx4 v14, s[12:15], s25 offen lds
  v_mfma_f32_16x16x32_bf16 a[96:99], v[188:191], v[64:67], a[96:99]
  v_mfma_f32_16x16x32_bf16 a[4:7], v[176:179], v[68:71], a[4:7]
  v_mfma_f32_16x16x32_bf16 a[36:39], v[180:183], v[68:71], a[36:39]
  ds_read_b64_tr_b16 v[162:163], v26 offset:8704
  s_add_u32 m0, s28, 1024
  s_nop 0
  buffer_load_dwordx4 v15, s[12:15], s25 offen lds
  v_mfma_f32_16x16x32_bf16 a[68:71], v[184:187], v[68:71], a[68:71]
  v_mfma_f32_16x16x32_bf16 a[100:103], v[188:191], v[68:71], a[100:103]
  s_add_u32 m0, s28, 2048
  s_nop 0
  buffer_load_dwordx4 v16, s[12:15], s25 offen lds
  v_mfma_f32_16x16x32_bf16 a[8:11], v[176:179], v[72:75], a[8:11]
  v_mfma_f32_16x16x32_bf16 a[40:43], v[180:183], v[72:75], a[40:43]
  ds_read_b64_tr_b16 v[164:165], v27 offset:8192
  v_mfma_f32_16x16x32_bf16 a[72:75], v[184:187], v[72:75], a[72:75]
  s_add_u32 m0, s28, 3072
  s_nop 0
  buffer_load_dwordx4 v17, s[12:15], s25 offen lds
  v_mfma_f32_16x16x32_bf16 a[104:107], v[188:191], v[72:75], a[104:107]
  v_mfma_f32_16x16x32_bf16 a[12:15], v[176:179], v[76:79], a[12:15]
  v_mfma_f32_16x16x32_bf16 a[44:47], v[180:183], v[76:79], a[44:47]
  ds_read_b64_tr_b16 v[166:167], v27 offset:8704
  buffer_load_dwordx4 v[32:35], v6, s[20:23], s26 offen
  v_mfma_f32_16x16x32_bf16 a[76:79], v[184:187], v[76:79], a[76:79]
  v_mfma_f32_16x16x32_bf16 a[108:111], v[188:191], v[76:79], a[108:111]
  buffer_load_dwordx4 v[36:39], v7, s[20:23], s26 offen
  v_mfma_f32_16x16x32_bf16 a[16:19], v[176:179], v[80:83], a[16:19]
  v_mfma_f32_16x16x32_bf16 a[48:51], v[180:183], v[80:83], a[48:51]
  ds_read_b64_tr_b16 v[168:169], v28 offset:8192
  v_mfma_f32_16x16x32_bf16 a[80:83], v[184:187], v[80:83], a[80:83]
  buffer_load_dwordx4 v[40:43], v8, s[20:23], s26 offen
  v_mfma_f32_16x16x32_bf16 a[112:115], v[188:191], v[80:83], a[112:115]
  v_mfma_f32_16x16x32_bf16 a[20:23], v[176:179], v[84:87], a[20:23]
  v_mfma_f32_16x16x32_bf16 a[52:55], v[180:183], v[84:87], a[52:55]
  ds_read_b64_tr_b16 v[170:171], v28 offset:8704
  buffer_load_dwordx4 v[44:47], v9, s[20:23], s26 offen
  v_mfma_f32_16x16x32_bf16 a[84:87], v[184:187], v[84:87], a[84:87]
  v_mfma_f32_16x16x32_bf16 a[116:119], v[188:191], v[84:87], a[116:119]
  buffer_load_dwordx4 v[48:51], v10, s[20:23], s26 offen
  v_mfma_f32_16x16x32_bf16 a[24:27], v[176:179], v[88:91], a[24:27]
  v_mfma_f32_16x16x32_bf16 a[56:59], v[180:183], v[88:91], a[56:59]
  ds_read_b64_tr_b16 v[172:173], v29 offset:8192
  v_mfma_f32_16x16x32_bf16 a[88:91], v[184:187], v[88:91], a[88:91]
  buffer_load_dwordx4 v[52:55], v11, s[20:23], s26 offen
  v_mfma_f32_16x16x32_bf16 a[120:123], v[188:191], v[88:91], a[120:123]
  v_mfma_f32_16x16x32_bf16 a[28:31], v[176:179], v[92:95], a[28:31]
  v_mfma_f32_16x16x32_bf16 a[60:63], v[180:183], v[92:95], a[60:63]
  ds_read_b64_tr_b16 v[174:175], v29 offset:8704
  buffer_load_dwordx4 v[56:59], v12, s[20:23], s26 offen
  v_mfma_f32_16x16x32_bf16 a[92:95], v[184:187], v[92:95], a[92:95]
  v_mfma_f32_16x16x32_bf16 a[124:127], v[188:191], v[92:95], a[124:127]
  buffer_load_dwordx4 v[60:63], v13, s[20:23], s26 offen
  s_add_u32 s25, s25, 65536
  s_add_u32 s26, s26, 1024
  s_waitcnt vmcnt(20) lgkmcnt(0)
  v_mfma_f32_16x16x32_bf16 a[0:3], v[160:163], v[96:99], a[0:3]
  v_mfma_f32_16x16x32_bf16 a[32:35], v[164:167], v[96:99], a[32:35]
  ds_read_b64_tr_b16 v[176:177], v26 offset:12288
  v_mfma_f32_16x16x32_bf16 a[64:67], v[168:171], v[96:99], a[64:67]
  s_add_u32 m0, s28, 4096
  s_nop 0
  buffer_load_dwordx4 v14, s[12:15], s25 offen lds
  v_mfma_f32_16x16x32_bf16 a[96:99], v[172:175], v[96:99], a[96:99]
  v_mfma_f32_16x16x32_bf16 a[4:7], v[160:163], v[100:103], a[4:7]
  v_mfma_f32_16x16x32_bf16 a[36:39], v[164:167], v[100:103], a[36:39]
  ds_read_b64_tr_b16 v[178:179], v26 offset:12800
  s_add_u32 m0, s28, 5120
  s_nop 0
  buffer_load_dwordx4 v15, s[12:15], s25 offen lds
  v_mfma_f32_16x16x32_bf16 a[68:71], v[168:171], v[100:103], a[68:71]
  v_mfma_f32_16x16x32_bf16 a[100:103], v[172:175], v[100:103], a[100:103]
  s_add_u32 m0, s28, 6144
  s_nop 0
  buffer_load_dwordx4 v16, s[12:15], s25 offen lds
  v_mfma_f32_16x16x32_bf16 a[8:11], v[160:163], v[104:107], a[8:11]
  v_mfma_f32_16x16x32_bf16 a[40:43], v[164:167], v[104:107], a[40:43]
  ds_read_b64_tr_b16 v[180:181], v27 offset:12288
  v_mfma_f32_16x16x32_bf16 a[72:75], v[168:171], v[104:107], a[72:75]
  s_add_u32 m0, s28, 7168
  s_nop 0
  buffer_load_dwordx4 v17, s[12:15], s25 offen lds
  v_mfma_f32_16x16x32_bf16 a[104:107], v[172:175], v[104:107], a[104:107]
  v_mfma_f32_16x16x32_bf16 a[12:15], v[160:163], v[108:111], a[12:15]
  v_mfma_f32_16x16x32_bf16 a[44:47], v[164:167], v[108:111], a[44:47]
  ds_read_b64_tr_b16 v[182:183], v27 offset:12800
  buffer_load_dwordx4 v[64:67], v6, s[20:23], s26 offen
  v_mfma_f32_16x16x32_bf16 a[76:79], v[168:171], v[108:111], a[76:79]
  v_mfma_f32_16x16x32_bf16 a[108:111], v[172:175], v[108:111], a[108:111]
  buffer_load_dwordx4 v[68:71], v7, s[20:23], s26 offen
  v_mfma_f32_16x16x32_bf16 a[16:19], v[160:163], v[112:115], a[16:19]
  v_mfma_f32_16x16x32_bf16 a[48:51], v[164:167], v[112:115], a[48:51]
  ds_read_b64_tr_b16 v[184:185], v28 offset:12288
  v_mfma_f32_16x16x32_bf16 a[80:83], v[168:171], v[112:115], a[80:83]
  buffer_load_dwordx4 v[72:75], v8, s[20:23], s26 offen
  v_mfma_f32_16x16x32_bf16 a[112:115], v[172:175], v[112:115], a[112:115]
  v_mfma_f32_16x16x32_bf16 a[20:23], v[160:163], v[116:119], a[20:23]
  v_mfma_f32_16x16x32_bf16 a[52:55], v[164:167], v[116:119], a[52:55]
  ds_read_b64_tr_b16 v[186:187], v28 offset:12800
  buffer_load_dwordx4 v[76:79], v9, s[20:23], s26 offen
  v_mfma_f32_16x16x32_bf16 a[84:87], v[168:171], v[116:119], a[84:87]
  v_mfma_f32_16x16x32_bf16 a[116:119], v[172:175], v[116:119], a[116:119]
  buffer_load_dwordx4 v[80:83], v10, s[20:23], s26 offen
  v_mfma_f32_16x16x32_bf16 a[24:27], v[160:163], v[120:123], a[24:27]
  v_mfma_f32_16x16x32_bf16 a[56:59], v[164:167], v[120:123], a[56:59]
  ds_read_b64_tr_b16 v[188:189], v29 offset:12288
  v_mfma_f32_16x16x32_bf16 a[88:91], v[168:171], v[120:123], a[88:91]
  buffer_load_dwordx4 v[84:87], v11, s[20:23], s26 offen
  v_mfma_f32_16x16x32_bf16 a[120:123], v[172:175], v[120:123], a[120:123]
  v_mfma_f32_16x16x32_bf16 a[28:31], v[160:163], v[124:127], a[28:31]
  v_mfma_f32_16x16x32_bf16 a[60:63], v[164:167], v[124:127], a[60:63]
  ds_read_b64_tr_b16 v[190:191], v29 offset:12800
  buffer_load_dwordx4 v[88:91], v12, s[20:23], s26 offen
  v_mfma_f32_16x16x32_bf16 a[92:95], v[168:171], v[124:127], a[92:95]
  v_mfma_f32_16x16x32_bf16 a[124:127], v[172:175], v[124:127], a[124:127]
  buffer_load_dwordx4 v[92:95], v13, s[20:23], s26 offen
  s_add_u32 s25, s25, 65536
  s_add_u32 s26, s26, 1024
  s_waitcnt vmcnt(20) lgkmcnt(0)
  v_mfma_f32_16x16x32_bf16 a[0:3], v[176:179], v[128:131], a[0:3]
  v_mfma_f32_16x16x32_bf16 a[32:35], v[180:183], v[128:131], a[32:35]
  ds_read_b64_tr_b16 v[160:161], v26 offset:0
  v_mfma_f32_16x16x32_bf16 a[64:67], v[184:187], v[128:131], a[64:67]
  s_add_u32 m0, s28, 8192
  s_nop 0
  buffer_load_dwordx4 v14, s[12:15], s25 offen lds
  v_mfma_f32_16x16x32_bf16 a[96:99], v[188:191], v[128:131], a[96:99]
  v_mfma_f32_16x16x32_bf16 a[4:7], v[176:179], v[132:135], a[4:7]
  v_mfma_f32_16x16x32_bf16 a[36:39], v[180:183], v[132:135], a[36:39]
  ds_read_b64_tr_b16 v[162:163], v26 offset:512
  s_add_u32 m0, s28, 9216
  s_nop 0
  buffer_load_dwordx4 v15, s[12:15], s25 offen lds
  v_mfma_f32_16x16x32_bf16 a[68:71], v[184:187], v[132:135], a[68:71]
  v_mfma_f32_16x16x32_bf16 a[100:103], v[188:191], v[132:135], a[100:103]
  s_add_u32 m0, s28, 10240
  s_nop 0
  buffer_load_dwordx4 v16, s[12:15], s25 offen lds
  v_mfma_f32_16x16x32_bf16 a[8:11], v[176:179], v[136:139], a[8:11]
  v_mfma_f32_16x16x32_bf16 a[40:43], v[180:183], v[136:139], a[40:43]
  ds_read_b64_tr_b16 v[164:165], v27 offset:0
  v_mfma_f32_16x16x32_bf16 a[72:75], v[184:187], v[136:139], a[72:75]
  s_add_u32 m0, s28, 11264
  s_nop 0
  buffer_load_dwordx4 v17, s[12:15], s25 offen lds
  v_mfma_f32_16x16x32_bf16 a[104:107], v[188:191], v[136:139], a[104:107]
  v_mfma_f32_16x16x32_bf16 a[12:15], v[176:179], v[140:143], a[12:15]
  v_mfma_f32_16x16x32_bf16 a[44:47], v[180:183], v[140:143], a[44:47]
  ds_read_b64_tr_b16 v[166:167], v27 offset:512
  buffer_load_dwordx4 v[96:99], v6, s[20:23], s26 offen
  v_mfma_f32_16x16x32_bf16 a[76:79], v[184:187], v[140:143], a[76:79]
  v_mfma_f32_16x16x32_bf16 a[108:111], v[188:191], v[140:143], a[108:111]
  buffer_load_dwordx4 v[100:103], v7, s[20:23], s26 offen
  v_mfma_f32_16x16x32_bf16 a[16:19], v[176:179], v[144:147], a[16:19]
  v_mfma_f32_16x16x32_bf16 a[48:51], v[180:183], v[144:147], a[48:51]
  ds_read_b64_tr_b16 v[168:169], v28 offset:0
  v_mfma_f32_16x16x32_bf16 a[80:83], v[184:187], v[144:147], a[80:83]
  buffer_load_dwordx4 v[104:107], v8, s[20:23], s26 offen
  v_mfma_f32_16x16x32_bf16 a[112:115], v[188:191], v[144:147], a[112:115]
  v_mfma_f32_16x16x32_bf16 a[20:23], v[176:179], v[148:151], a[20:23]
  v_mfma_f32_16x16x32_bf16 a[52:55], v[180:183], v[148:151], a[52:55]
  ds_read_b64_tr_b16 v[170:171], v28 offset:512
  buffer_load_dwordx4 v[108:111], v9, s[20:23], s26 offen
  v_mfma_f32_16x16x32_bf16 a[84:87], v[184:187], v[148:151], a[84:87]
  v_mfma_f32_16x16x32_bf16 a[116:119], v[188:191], v[148:151], a[116:119]
  buffer_load_dwordx4 v[112:115], v10, s[20:23], s26 offen
  v_mfma_f32_16x16x32_bf16 a[24:27], v[176:179], v[152:155], a[24:27]
  v_mfma_f32_16x16x32_bf16 a[56:59], v[180:183], v[152:155], a[56:59]
  ds_read_b64_tr_b16 v[172:173], v29 offset:0
  v_mfma_f32_16x16x32_bf16 a[88:91], v[184:187], v[152:155], a[88:91]
  buffer_load_dwordx4 v[116:119], v11, s[20:23], s26 offen
  v_mfma_f32_16x16x32_bf16 a[120:123], v[188:191], v[152:155], a[120:123]
  v_mfma_f32_16x16x32_bf16 a[28:31], v[176:179], v[156:159], a[28:31]
  v_mfma_f32_16x16x32_bf16 a[60:63], v[180:183], v[156:159], a[60:63]
  ds_read_b64_tr_b16 v[174:175], v29 offset:512
  buffer_load_dwordx4 v[120:123], v12, s[20:23], s26 offen
  v_mfma_f32_16x16x32_bf16 a[92:95], v[184:187], v[156:159], a[92:95]
  v_mfma_f32_16x16x32_bf16 a[124:127], v[188:191], v[156:159], a[124:127]
  buffer_load_dwordx4 v[124:127], v13, s[20:23], s26 offen
  s_add_u32 s25, s25, 65536
  s_add_u32 s26, s26, 1024
  s_add_u32 s27, s27, 1
  s_cmp_lt_u32 s27, 7
  s_cbranch_scc1 G2_loop
  s_waitcnt vmcnt(0) lgkmcnt(0)
  s_barrier
  v_lshlrev_b32 v6, 11, v2
  v_lshl_add_u32 v6, v3, 3, v6
  s_lshl_b32 s25, s24, 5
  s_add_u32 s25, s25, s29
  s_lshl_b32 s25, s25, 11
  s_lshl_b32 s26, s30, 1
  s_add_u32 s25, s25, s26
  s_add_u32 s26, s25, 0x1000000
  buffer_load_dwordx2 v[160:161], v6, s[20:23], s26 offen offset:0
  buffer_load_dwordx2 v[162:163], v6, s[20:23], s26 offen offset:32
  buffer_load_dwordx2 v[164:165], v6, s[20:23], s26 offen offset:64
  buffer_load_dwordx2 v[166:167], v6, s[20:23], s26 offen offset:96
  s_add_u32 s26, s26, 32768
  buffer_load_dwordx2 v[168:169], v6, s[20:23], s26 offen offset:0
  buffer_load_dwordx2 v[170:171], v6, s[20:23], s26 offen offset:32
  buffer_load_dwordx2 v[172:173], v6, s[20:23], s26 offen offset:64
  buffer_load_dwordx2 v[174:175], v6, s[20:23], s26 offen offset:96
  s_add_u32 s26, s26, 32768
  v_lshlrev_b32 v18, 4, v1
  s_lshl_b32 s27, s24, 15
  v_add_u32 v19, s27, v18
  s_nop 7
  v_accvgpr_read_b32 v32, a0
  v_accvgpr_read_b32 v33, a1
  v_accvgpr_read_b32 v34, a2
  v_accvgpr_read_b32 v35, a3
  ds_write_b128 v19, v[32:35] offset:0
  v_accvgpr_read_b32 v36, a4
  v_accvgpr_read_b32 v37, a5
  v_accvgpr_read_b32 v38, a6
  v_accvgpr_read_b32 v39, a7
  ds_write_b128 v19, v[36:39] offset:1024
  v_accvgpr_read_b32 v40, a8
  v_accvgpr_read_b32 v41, a9
  v_accvgpr_read_b32 v42, a10
  v_accvgpr_read_b32 v43, a11
  ds_write_b128 v19, v[40:43] offset:2048
  v_accvgpr_read_b32 v44, a12
  v_accvgpr_read_b32 v45, a13
  v_accvgpr_read_b32 v46, a14
  v_accvgpr_read_b32 v47, a15
  ds_write_b128 v19, v[44:47] offset:3072
  v_accvgpr_read_b32 v48, a16
  v_accvgpr_read_b32 v49, a17
  v_accvgpr_read_b32 v50, a18
  v_accvgpr_read_b32 v51, a19
  ds_write_b128 v19, v[48:51] offset:4096
  v_accvgpr_read_b32 v52, a20
  v_accvgpr_read_b32 v53, a21
  v_accvgpr_read_b32 v54, a22
  v_accvgpr_read_b32 v55, a23
  ds_write_b128 v19, v[52:55] offset:5120
  v_accvgpr_read_b32 v56, a24
  v_accvgpr_read_b32 v57, a25
  v_accvgpr_read_b32 v58, a26
  v_accvgpr_read_b32 v59, a27
  ds_write_b128 v19, v[56:59] offset:6144
  v_accvgpr_read_b32 v60, a28
  v_accvgpr_read_b32 v61, a29
  v_accvgpr_read_b32 v62, a30
  v_accvgpr_read_b32 v63, a31
  ds_write_b128 v19, v[60:63] offset:7168
  v_accvgpr_read_b32 v32, a32
  v_accvgpr_read_b32 v33, a33
  v_accvgpr_read_b32 v34, a34
  v_accvgpr_read_b32 v35, a35
  ds_write_b128 v19, v[32:35] offset:8192
  v_accvgpr_read_b32 v36, a36
  v_accvgpr_read_b32 v37, a37
  v_accvgpr_read_b32 v38, a38
  v_accvgpr_read_b32 v39, a39
  ds_write_b128 v19, v[36:39] offset:9216
  v_accvgpr_read_b32 v40, a40
  v_accvgpr_read_b32 v41, a41
  v_accvgpr_read_b32 v42, a42
  v_accvgpr_read_b32 v43, a43
  ds_write_b128 v19, v[40:43] offset:10240
  v_accvgpr_read_b32 v44, a44
  v_accvgpr_read_b32 v45, a45
  v_accvgpr_read_b32 v46, a46
  v_accvgpr_read_b32 v47, a47
  ds_write_b128 v19, v[44:47] offset:11264
  v_accvgpr_read_b32 v48, a48
  v_accvgpr_read_b32 v49, a49
  v_accvgpr_read_b32 v50, a50
  v_accvgpr_read_b32 v51, a51
  ds_write_b128 v19, v[48:51] offset:12288
  v_accvgpr_read_b32 v52, a52
  v_accvgpr_read_b32 v53, a53
  v_accvgpr_read_b32 v54, a54
  v_accvgpr_read_b32 v55, a55
  ds_write_b128 v19, v[52:55] offset:13312
  v_accvgpr_read_b32 v56, a56
  v_accvgpr_read_b32 v57, a57
  v_accvgpr_read_b32 v58, a58
  v_accvgpr_read_b32 v59, a59
  ds_write_b128 v19, v[56:59] offset:14336
  v_accvgpr_read_b32 v60, a60
  v_accvgpr_read_b32 v61, a61
  v_accvgpr_read_b32 v62, a62
  v_accvgpr_read_b32 v63, a63
  ds_write_b128 v19, v[60:63] offset:15360
  v_accvgpr_read_b32 v32, a64
  v_accvgpr_read_b32 v33, a65
  v_accvgpr_read_b32 v34, a66
  v_accvgpr_read_b32 v35, a67
  ds_write_b128 v19, v[32:35] offset:16384
  v_accvgpr_read_b32 v36, a68
  v_accvgpr_read_b32 v37, a69
  v_accvgpr_read_b32 v38, a70
  v_accvgpr_read_b32 v39, a71
  ds_write_b128 v19, v[36:39] offset:17408
  v_accvgpr_read_b32 v40, a72
  v_accvgpr_read_b32 v41, a73
  v_accvgpr_read_b32 v42, a74
  v_accvgpr_read_b32 v43, a75
  ds_write_b128 v19, v[40:43] offset:18432
  v_accvgpr_read_b32 v44, a76
  v_accvgpr_read_b32 v45, a77
  v_accvgpr_read_b32 v46, a78
  v_accvgpr_read_b32 v47, a79
  ds_write_b128 v19, v[44:47] offset:19456
  v_accvgpr_read_b32 v48, a80
  v_accvgpr_read_b32 v49, a81
  v_accvgpr_read_b32 v50, a82
  v_accvgpr_read_b32 v51, a83
  ds_write_b128 v19, v[48:51] offset:20480
  v_accvgpr_read_b32 v52, a84
  v_accvgpr_read_b32 v53, a85
  v_accvgpr_read_b32 v54, a86
  v_accvgpr_read_b32 v55, a87
  ds_write_b128 v19, v[52:55] offset:21504
  v_accvgpr_read_b32 v56, a88
  v_accvgpr_read_b32 v57, a89
  v_accvgpr_read_b32 v58, a90
  v_accvgpr_read_b32 v59, a91
  ds_write_b128 v19, v[56:59] offset:22528
  v_accvgpr_read_b32 v60, a92
  v_accvgpr_read_b32 v61, a93
  v_accvgpr_read_b32 v62, a94
  v_accvgpr_read_b32 v63, a95
  ds_write_b128 v19, v[60:63] offset:23552
  v_accvgpr_read_b32 v32, a96
  v_accvgpr_read_b32 v33, a97
  v_accvgpr_read_b32 v34, a98
  v_accvgpr_read_b32 v35, a99
  ds_write_b128 v19, v[32:35] offset:24576
  v_accvgpr_read_b32 v36, a100
  v_accvgpr_read_b32 v37, a101
  v_accvgpr_read_b32 v38, a102
  v_accvgpr_read_b32 v39, a103
  ds_write_b128 v19, v[36:39] offset:25600
  v_accvgpr_read_b32 v40, a104
  v_accvgpr_read_b32 v41, a105
  v_accvgpr_read_b32 v42, a106
  v_accvgpr_read_b32 v43, a107
  ds_write_b128 v19, v[40:43] offset:26624
  v_accvgpr_read_b32 v44, a108
  v_accvgpr_read_b32 v45, a109
  v_accvgpr_read_b32 v46, a110
  v_accvgpr_read_b32 v47, a111
  ds_write_b128 v19, v[44:47] offset:27648
  v_accvgpr_read_b32 v48, a112
  v_accvgpr_read_b32 v49, a113
  v_accvgpr_read_b32 v50, a114
  v_accvgpr_read_b32 v51, a115
  ds_write_b128 v19, v[48:51] offset:28672
  v_accvgpr_read_b32 v52, a116
  v_accvgpr_read_b32 v53, a117
  v_accvgpr_read_b32 v54, a118
  v_accvgpr_read_b32 v55, a119
  ds_write_b128 v19, v[52:55] offset:29696
  v_accvgpr_read_b32 v56, a120
  v_accvgpr_read_b32 v57, a121
  v_accvgpr_read_b32 v58, a122
  v_accvgpr_read_b32 v59, a123
  ds_write_b128 v19, v[56:59] offset:30720
  v_accvgpr_read_b32 v60, a124
  v_accvgpr_read_b32 v61, a125
  v_accvgpr_read_b32 v62, a126
  v_accvgpr_read_b32 v63, a127
  ds_write_b128 v19, v[60:63] offset:31744
  s_waitcnt lgkmcnt(0)
  s_barrier
  s_lshl_b32 s27, s24, 11
  v_add_u32 v19, s27, v18
  v_add_u32 v20, 0x10000, v19
  ds_read_b128 v[32:35], v19 offset:0
  ds_read_b128 v[36:39], v19 offset:32768
  ds_read_b128 v[40:43], v20 offset:0
  ds_read_b128 v[44:47], v20 offset:32768
  ds_read_b128 v[48:51], v19 offset:8192
  ds_read_b128 v[52:55], v19 offset:40960
  ds_read_b128 v[56:59], v20 offset:8192
  ds_read_b128 v[60:63], v20 offset:40960
  ds_read_b128 v[64:67], v19 offset:16384
  ds_read_b128 v[68:71], v19 offset:49152
  ds_read_b128 v[72:75], v20 offset:16384
  ds_read_b128 v[76:79], v20 offset:49152
  ds_read_b128 v[80:83], v19 offset:24576
  ds_read_b128 v[84:87], v19 offset:57344
  ds_read_b128 v[88:91], v20 offset:24576
  ds_read_b128 v[92:95], v20 offset:57344
  ds_read_b128 v[96:99], v19 offset:1024
  ds_read_b128 v[100:103], v19 offset:33792
  ds_read_b128 v[104:107], v20 offset:1024
  ds_read_b128 v[108:111], v20 offset:33792
  ds_read_b128 v[112:115], v19 offset:9216
  ds_read_b128 v[116:119], v19 offset:41984
  ds_read_b128 v[120:123], v20 offset:9216
  ds_read_b128 v[124:127], v20 offset:41984
  ds_read_b128 v[128:131], v19 offset:17408
  ds_read_b128 v[132:135], v19 offset:50176
  ds_read_b128 v[136:139], v20 offset:17408
  ds_read_b128 v[140:143], v20 offset:50176
  ds_read_b128 v[144:147], v19 offset:25600
  ds_read_b128 v[148:151], v19 offset:58368
  ds_read_b128 v[152:155], v20 offset:25600
  ds_read_b128 v[156:159], v20 offset:58368
  s_waitcnt vmcnt(0) lgkmcnt(0)
  v_add_f32 v32, v32, v36
  v_add_f32 v40, v40, v44
  v_add_f32 v32, v32, v40
  v_add_f32 v33, v33, v37
  v_add_f32 v41, v41, v45
  v_add_f32 v33, v33, v41
  v_add_f32 v34, v34, v38
  v_add_f32 v42, v42, v46
  v_add_f32 v34, v34, v42
  v_add_f32 v35, v35, v39
  v_add_f32 v43, v43, v47
  v_add_f32 v35, v35, v43
  v_cvt_pk_bf16_f32 v36, v32, v33
  v_lshlrev_b32 v37, 16, v36
  v_and_b32 v38, 0xffff0000, v36
  v_lshlrev_b32 v39, 16, v160
  v_add_f32 v37, v37, v39
  v_and_b32 v39, 0xffff0000, v160
  v_add_f32 v38, v38, v39
  v_cvt_pk_bf16_f32 v40, v37, v38
  v_cvt_pk_bf16_f32 v36, v34, v35
  v_lshlrev_b32 v37, 16, v36
  v_and_b32 v38, 0xffff0000, v36
  v_lshlrev_b32 v39, 16, v161
  v_add_f32 v37, v37, v39
  v_and_b32 v39, 0xffff0000, v161
  v_add_f32 v38, v38, v39
  v_cvt_pk_bf16_f32 v41, v37, v38
  buffer_store_dwordx2 v[40:41], v6, s[16:19], s25 offen offset:0
  v_add_f32 v48, v48, v52
  v_add_f32 v56, v56, v60
  v_add_f32 v48, v48, v56
  v_add_f32 v49, v49, v53
  v_add_f32 v57, v57, v61
  v_add_f32 v49, v49, v57
  v_add_f32 v50, v50, v54
  v_add_f32 v58, v58, v62
  v_add_f32 v50, v50, v58
  v_add_f32 v51, v51, v55
  v_add_f32 v59, v59, v63
  v_add_f32 v51, v51, v59
  v_cvt_pk_bf16_f32 v52, v48, v49
  v_lshlrev_b32 v53, 16, v52
  v_and_b32 v54, 0xffff0000, v52
  v_lshlrev_b32 v55, 16, v162
  v_add_f32 v53, v53, v55
  v_and_b32 v55, 0xffff0000, v162
  v_add_f32 v54, v54, v55
  v_cvt_pk_bf16_f32 v56, v53, v54
  v_cvt_pk_bf16_f32 v52, v50, v51
  v_lshlrev_b32 v53, 16, v52
  v_and_b32 v54, 0xffff0000, v52
  v_lshlrev_b32 v55, 16, v163
  v_add_f32 v53, v53, v55
  v_and_b32 v55, 0xffff0000, v163
  v_add_f32 v54, v54, v55
  v_cvt_pk_bf16_f32 v57, v53, v54
  buffer_store_dwordx2 v[56:57], v6, s[16:19], s25 offen offset:32
  v_add_f32 v64, v64, v68
  v_add_f32 v72, v72, v76
  v_add_f32 v64, v64, v72
  v_add_f32 v65, v65, v69
  v_add_f32 v73, v73, v77
  v_add_f32 v65, v65, v73
  v_add_f32 v66, v66, v70
  v_add_f32 v74, v74, v78
  v_add_f32 v66, v66, v74
  v_add_f32 v67, v67, v71
  v_add_f32 v75, v75, v79
  v_add_f32 v67, v67, v75
  v_cvt_pk_bf16_f32 v68, v64, v65
  v_lshlrev_b32 v69, 16, v68
  v_and_b32 v70, 0xffff0000, v68
  v_lshlrev_b32 v71, 16, v164
  v_add_f32 v69, v69, v71
  v_and_b32 v71, 0xffff0000, v164
  v_add_f32 v70, v70, v71
  v_cvt_pk_bf16_f32 v72, v69, v70
  v_cvt_pk_bf16_f32 v68, v66, v67
  v_lshlrev_b32 v69, 16, v68
  v_and_b32 v70, 0xffff0000, v68
  v_lshlrev_b32 v71, 16, v165
  v_add_f32 v69, v69, v71
  v_and_b32 v71, 0xffff0000, v165
  v_add_f32 v70, v70, v71
  v_cvt_pk_bf16_f32 v73, v69, v70
  buffer_store_dwordx2 v[72:73], v6, s[16:19], s25 offen offset:64
  v_add_f32 v80, v80, v84
  v_add_f32 v88, v88, v92
  v_add_f32 v80, v80, v88
  v_add_f32 v81, v81, v85
  v_add_f32 v89, v89, v93
  v_add_f32 v81, v81, v89
  v_add_f32 v82, v82, v86
  v_add_f32 v90, v90, v94
  v_add_f32 v82, v82, v90
  v_add_f32 v83, v83, v87
  v_add_f32 v91, v91, v95
  v_add_f32 v83, v83, v91
  v_cvt_pk_bf16_f32 v84, v80, v81
  v_lshlrev_b32 v85, 16, v84
  v_and_b32 v86, 0xffff0000, v84
  v_lshlrev_b32 v87, 16, v166
  v_add_f32 v85, v85, v87
  v_and_b32 v87, 0xffff0000, v166
  v_add_f32 v86, v86, v87
  v_cvt_pk_bf16_f32 v88, v85, v86
  v_cvt_pk_bf16_f32 v84, v82, v83
  v_lshlrev_b32 v85, 16, v84
  v_and_b32 v86, 0xffff0000, v84
  v_lshlrev_b32 v87, 16, v167
  v_add_f32 v85, v85, v87
  v_and_b32 v87, 0xffff0000, v167
  v_add_f32 v86, v86, v87
  v_cvt_pk_bf16_f32 v89, v85, v86
  buffer_store_dwordx2 v[88:89], v6, s[16:19], s25 offen offset:96
  s_add_u32 s25, s25, 32768
  v_add_f32 v96, v96, v100
  v_add_f32 v104, v104, v108
  v_add_f32 v96, v96, v104
  v_add_f32 v97, v97, v101
  v_add_f32 v105, v105, v109
  v_add_f32 v97, v97, v105
  v_add_f32 v98, v98, v102
  v_add_f32 v106, v106, v110
  v_add_f32 v98, v98, v106
  v_add_f32 v99, v99, v103
  v_add_f32 v107, v107, v111
  v_add_f32 v99, v99, v107
  v_cvt_pk_bf16_f32 v100, v96, v97
  v_lshlrev_b32 v101, 16, v100
  v_and_b32 v102, 0xffff0000, v100
  v_lshlrev_b32 v103, 16, v168
  v_add_f32 v101, v101, v103
  v_and_b32 v103, 0xffff0000, v168
  v_add_f32 v102, v102, v103
  v_cvt_pk_bf16_f32 v104, v101, v102
  v_cvt_pk_bf16_f32 v100, v98, v99
  v_lshlrev_b32 v101, 16, v100
  v_and_b32 v102, 0xffff0000, v100
  v_lshlrev_b32 v103, 16, v169
  v_add_f32 v101, v101, v103
  v_and_b32 v103, 0xffff0000, v169
  v_add_f32 v102, v102, v103
  v_cvt_pk_bf16_f32 v105, v101, v102
  buffer_store_dwordx2 v[104:105], v6, s[16:19], s25 offen offset:0
  v_add_f32 v112, v112, v116
  v_add_f32 v120, v120, v124
  v_add_f32 v112, v112, v120
  v_add_f32 v113, v113, v117
  v_add_f32 v121, v121, v125
  v_add_f32 v113, v113, v121
  v_add_f32 v114, v114, v118
  v_add_f32 v122, v122, v126
  v_add_f32 v114, v114, v122
  v_add_f32 v115, v115, v119
  v_add_f32 v123, v123, v127
  v_add_f32 v115, v115, v123
  v_cvt_pk_bf16_f32 v116, v112, v113
  v_lshlrev_b32 v117, 16, v116
  v_and_b32 v118, 0xffff0000, v116
  v_lshlrev_b32 v119, 16, v170
  v_add_f32 v117, v117, v119
  v_and_b32 v119, 0xffff0000, v170
  v_add_f32 v118, v118, v119
  v_cvt_pk_bf16_f32 v120, v117, v118
  v_cvt_pk_bf16_f32 v116, v114, v115
  v_lshlrev_b32 v117, 16, v116
  v_and_b32 v118, 0xffff0000, v116
  v_lshlrev_b32 v119, 16, v171
  v_add_f32 v117, v117, v119
  v_and_b32 v119, 0xffff0000, v171
  v_add_f32 v118, v118, v119
  v_cvt_pk_bf16_f32 v121, v117, v118
  buffer_store_dwordx2 v[120:121], v6, s[16:19], s25 offen offset:32
  v_add_f32 v128, v128, v132
  v_add_f32 v136, v136, v140
  v_add_f32 v128, v128, v136
  v_add_f32 v129, v129, v133
  v_add_f32 v137, v137, v141
  v_add_f32 v129, v129, v137
  v_add_f32 v130, v130, v134
  v_add_f32 v138, v138, v142
  v_add_f32 v130, v130, v138
  v_add_f32 v131, v131, v135
  v_add_f32 v139, v139, v143
  v_add_f32 v131, v131, v139
  v_cvt_pk_bf16_f32 v132, v128, v129
  v_lshlrev_b32 v133, 16, v132
  v_and_b32 v134, 0xffff0000, v132
  v_lshlrev_b32 v135, 16, v172
  v_add_f32 v133, v133, v135
  v_and_b32 v135, 0xffff0000, v172
  v_add_f32 v134, v134, v135
  v_cvt_pk_bf16_f32 v136, v133, v134
  v_cvt_pk_bf16_f32 v132, v130, v131
  v_lshlrev_b32 v133, 16, v132
  v_and_b32 v134, 0xffff0000, v132
  v_lshlrev_b32 v135, 16, v173
  v_add_f32 v133, v133, v135
  v_and_b32 v135, 0xffff0000, v173
  v_add_f32 v134, v134, v135
  v_cvt_pk_bf16_f32 v137, v133, v134
  buffer_store_dwordx2 v[136:137], v6, s[16:19], s25 offen offset:64
  v_add_f32 v144, v144, v148
  v_add_f32 v152, v152, v156
  v_add_f32 v144, v144, v152
  v_add_f32 v145, v145, v149
  v_add_f32 v153, v153, v157
  v_add_f32 v145, v145, v153
  v_add_f32 v146, v146, v150
  v_add_f32 v154, v154, v158
  v_add_f32 v146, v146, v154
  v_add_f32 v147, v147, v151
  v_add_f32 v155, v155, v159
  v_add_f32 v147, v147, v155
  v_cvt_pk_bf16_f32 v148, v144, v145
  v_lshlrev_b32 v149, 16, v148
  v_and_b32 v150, 0xffff0000, v148
  v_lshlrev_b32 v151, 16, v174
  v_add_f32 v149, v149, v151
  v_and_b32 v151, 0xffff0000, v174
  v_add_f32 v150, v150, v151
  v_cvt_pk_bf16_f32 v152, v149, v150
  v_cvt_pk_bf16_f32 v148, v146, v147
  v_lshlrev_b32 v149, 16, v148
  v_and_b32 v150, 0xffff0000, v148
  v_lshlrev_b32 v151, 16, v175
  v_add_f32 v149, v149, v151
  v_and_b32 v151, 0xffff0000, v175
  v_add_f32 v150, v150, v151
  v_cvt_pk_bf16_f32 v153, v149, v150
  buffer_store_dwordx2 v[152:153], v6, s[16:19], s25 offen offset:96
  s_add_u32 s25, s25, 32768
  s_waitcnt vmcnt(0) lgkmcnt(0)
G2_done:
  s_endpgm
.section .rodata,"a"
.p2align 6
.amdhsa_kernel fftA_kernel
  .amdhsa_next_free_vgpr 124
  .amdhsa_next_free_sgpr 102
  .amdhsa_accum_offset 124
  .amdhsa_group_segment_fixed_size 0
  .amdhsa_kernarg_size 80
  .amdhsa_user_sgpr_count 2
  .amdhsa_user_sgpr_kernarg_segment_ptr 1
  .amdhsa_system_sgpr_workgroup_id_x 1
.end_amdhsa_kernel
.p2align 6
.amdhsa_kernel fftB_kernel
  .amdhsa_next_free_vgpr 472
  .amdhsa_next_free_sgpr 102
  .amdhsa_accum_offset 256
  .amdhsa_group_segment_fixed_size 0
  .amdhsa_kernarg_size 80
  .amdhsa_user_sgpr_count 2
  .amdhsa_user_sgpr_kernarg_segment_ptr 1
  .amdhsa_system_sgpr_workgroup_id_x 1
.end_amdhsa_kernel
.p2align 6
.amdhsa_kernel fftC_kernel
  .amdhsa_next_free_vgpr 156
  .amdhsa_next_free_sgpr 102
  .amdhsa_accum_offset 156
  .amdhsa_group_segment_fixed_size 0
  .amdhsa_kernarg_size 80
  .amdhsa_user_sgpr_count 2
  .amdhsa_user_sgpr_kernarg_segment_ptr 1
  .amdhsa_system_sgpr_workgroup_id_x 1
.end_amdhsa_kernel
.p2align 6
.amdhsa_kernel ffn1_kernel
  .amdhsa_next_free_vgpr 216
  .amdhsa_next_free_sgpr 102
  .amdhsa_accum_offset 104
  .amdhsa_group_segment_fixed_size 0
  .amdhsa_kernarg_size 80
  .amdhsa_user_sgpr_count 2
  .amdhsa_user_sgpr_kernarg_segment_ptr 1
  .amdhsa_system_sgpr_workgroup_id_x 1
.end_amdhsa_kernel
.p2align 6
.amdhsa_kernel ffn2_kernel
  .amdhsa_next_free_vgpr 320
  .amdhsa_next_free_sgpr 102
  .amdhsa_accum_offset 192
  .amdhsa_group_segment_fixed_size 0
  .amdhsa_kernarg_size 80
  .amdhsa_user_sgpr_count 2
  .amdhsa_user_sgpr_kernarg_segment_ptr 1
  .amdhsa_system_sgpr_workgroup_id_x 1
.end_amdhsa_kernel
```
